```python
import torch

def _softmax(x, axis=-1):
    return torch.softmax(x, dim=axis)
def _gelu(x):
    return torch.nn.functional.gelu(x, approximate="tanh")
def _silu(x):
    return torch.nn.functional.silu(x)
def _sigmoid(x):
    return torch.sigmoid(x)
def _layernorm(x, axis=-1, eps=1e-5):
    m = x.mean(dim=axis, keepdim=True)
    v = x.var(dim=axis, keepdim=True, unbiased=False)
    return (x - m) / torch.sqrt(v + eps)
def _scatter_add(tgt, idx, src, axis=0):
    return tgt.clone().index_add_(axis, idx, src)
def _segment_sum(src, seg, n):
    out = torch.zeros((n,) + src.shape[1:], dtype=src.dtype)
    return out.index_add_(0, seg, src)
def _pad(x, pw):
    flat = tuple(v for pair in reversed(pw) for v in pair)
    return torch.nn.functional.pad(x, flat)

kernel_name = 'concat_heads__sliding_block__spectral_fnet__prompt'

def setup_inputs():

    _w = (lambda a: (lambda t: t.to(torch.bfloat16) if t.is_floating_point() else t)(torch.as_tensor(a)))
    def _A_setup():
        B, S, D = 1, 2048, 448
        return {
            "x": _w((lambda *s: torch.randn(*s, dtype=torch.bfloat16) * 0.2)(B, S, D)),
            "wqkv": _w((lambda *s: torch.randn(*s, dtype=torch.bfloat16) * 0.8)(D, 3 * D)),
            "wo": _w((lambda *s: torch.randn(*s, dtype=torch.bfloat16) * 0.2)(D, D)),
        }
    _A_in = _A_setup()

    def _B_setup():
        B, S, D = 1, 2048, 448
        ns = torch.arange(S)[:, None] * torch.arange(S)[None, :]
        nd = torch.arange(D)[:, None] * torch.arange(D)[None, :]
        Ws_re = torch.cos(-2.0 * torch.pi * ns / S).to(float)
        Ws_im = torch.sin(-2.0 * torch.pi * ns / S).to(float)
        Wd_re = torch.cos(-2.0 * torch.pi * nd / D).to(float)
        Wd_im = torch.sin(-2.0 * torch.pi * nd / D).to(float)
        return {
            "x": _w((lambda *s: torch.randn(*s, dtype=torch.bfloat16) * 0.05)(B, S, D)),
            "dft_seq_re": _w(Ws_re),
            "dft_seq_im": _w(Ws_im),
            "dft_hid_re": _w(Wd_re),
            "dft_hid_im": _w(Wd_im),
        }
    _B_in = _B_setup()

    return {
        "A_x": _A_in["x"],
        "A_wqkv": _A_in["wqkv"],
        "A_wo": _A_in["wo"],
        "B_x": _B_in["x"],
        "B_dft_seq_re": _B_in["dft_seq_re"],
        "B_dft_seq_im": _B_in["dft_seq_im"],
        "B_dft_hid_re": _B_in["dft_hid_re"],
        "B_dft_hid_im": _B_in["dft_hid_im"],
    }

def reference(A_x, A_wqkv, A_wo, B_x, B_dft_seq_re, B_dft_seq_im, B_dft_hid_re, B_dft_hid_im):
    def _A_ref(x, wqkv, wo):
        B, S, D = x.shape
        H = 16; Dh = D // H; W = 256
        qkv = (lambda x, *d: x.permute(*d))((x @ wqkv).reshape(B, S, 3, H, Dh), 2, 0, 3, 1, 4)
        q, k, v = qkv[0], qkv[1], qkv[2]
        scores = torch.einsum("bhqd,bhkd->bhqk", q, k) * (Dh ** -0.5)
        idx = torch.arange(S)
        mask = (idx[:, None] - idx[None, :] >= 0) & (idx[:, None] - idx[None, :] < W)
        scores = torch.where(mask[None, None], scores, -1e9)
        p = _softmax(scores, axis=-1)
        o = torch.einsum("bhqk,bhkd->bhqd", p, v)
        return (lambda x, *d: x.permute(*d))(o, 0, 2, 1, 3).reshape(B, S, D) @ wo

    def _B_ref(x, dft_seq_re, dft_seq_im, dft_hid_re, dft_hid_im):
        a = torch.einsum("bsd,ed->bse", x, dft_hid_re)
        b = torch.einsum("bsd,ed->bse", x, dft_hid_im)
        y = torch.einsum("ts,bse->bte", dft_seq_re, a) - torch.einsum("ts,bse->bte", dft_seq_im, b)
        return y

    a = _A_ref(A_x, A_wqkv, A_wo)
    b = _B_ref(B_x, B_dft_seq_re, B_dft_seq_im, B_dft_hid_re, B_dft_hid_im)
    return torch.concatenate([a, b], axis=-1)
```

```asm
; @launch grid=(256,1,1) block=(512,1,1) lds=163840
.amdgcn_target "amdgcn-amd-amdhsa--gfx950"
.text
.globl concat_heads__sliding_block__spectral_fnet__prompt_kernel
.p2align 8
.type concat_heads__sliding_block__spectral_fnet__prompt_kernel,@function
concat_heads__sliding_block__spectral_fnet__prompt_kernel:
    s_cmp_ge_u32 s2, 256
    s_cbranch_scc1 k_end
    s_load_dwordx16 s[16:31], s[0:1], 0
    s_load_dwordx4 s[32:35], s[0:1], 64
    s_load_dwordx2 s[36:37], s[0:1], 80
    v_and_b32 v1, 63, v0
    v_lshrrev_b32 v2, 6, v0
    s_and_b32 s4, s2, 7
    v_readfirstlane_b32 s15, v2
    s_lshr_b32 s5, s2, 3
    s_and_b32 s6, s4, 3
    s_lshl_b32 s6, s6, 2
    s_and_b32 s14, s5, 3
    s_add_u32 s6, s6, s14
    s_lshr_b32 s7, s4, 2
    s_lshl_b32 s7, s7, 2
    s_bfe_u32 s13, s5, 0x20002
    s_add_u32 s7, s7, s13
    s_add_u32 s8, s14, s13
    s_lshl_b32 s8, s8, 1
    s_cmp_ge_u32 s8, 7
    s_cselect_b32 s14, 7, 0
    s_sub_u32 s8, s8, s14
    s_and_b32 s3, s15, 3
    s_cmp_lt_u32 s15, 4
    s_cbranch_scc1 g0_entry
    s_cmp_ge_u32 s5, 16
    s_cbranch_scc1 g1_p1b
    s_lshl_b32 s11, s6, 7
    s_lshl_b32 s14, s3, 5
    s_add_u32 s11, s11, s14
    v_lshrrev_b32 v17, 3, v1
    v_add_u32 v17, s11, v17
    v_mul_u32_u24 v17, 896, v17
    v_and_b32 v18, 7, v1
    v_lshrrev_b32 v19, 4, v1
    v_xor_b32 v18, v18, v19
    v_lshl_add_u32 v4, v18, 4, v17
    v_xor_b32 v18, 4, v18
    v_lshl_add_u32 v5, v18, 4, v17
    v_add_u32 v5, 7168, v5
    v_add_u32 v6, 14336, v4
    v_add_u32 v7, 14336, v5
    s_lshl_b32 s12, s3, 12
    s_lshl_b32 s9, s8, 7
    s_waitcnt lgkmcnt(0)
    s_mov_b32 s40, s16
    s_and_b32 s41, s17, 0xffff
    s_mov_b32 s42, 1835008
    s_mov_b32 s43, 0x20000
    s_add_u32 m0, s12, 0
    s_nop 0
    buffer_load_dwordx4 v4, s[40:43], s9 offen lds
    s_add_u32 m0, s12, 1024
    s_nop 0
    buffer_load_dwordx4 v5, s[40:43], s9 offen lds
    s_add_u32 m0, s12, 2048
    s_nop 0
    buffer_load_dwordx4 v6, s[40:43], s9 offen lds
    s_add_u32 m0, s12, 3072
    s_nop 0
    buffer_load_dwordx4 v7, s[40:43], s9 offen lds
    s_mov_b32 s44, s18
    s_and_b32 s45, s19, 0xffff
    s_mov_b32 s46, 1204224
    s_mov_b32 s47, 0x20000
    s_mul_i32 s11, s3, 43008
    s_mul_i32 s14, s7, 336
    s_add_u32 s11, s11, s14
    s_mul_i32 s13, s3, 5376
    s_add_u32 s13, s13, 16384
    s_mul_i32 s10, s8, 172032
    v_add_u32 v17, 0, v1
    v_mul_u32_u24 v18, 3121, v17
    v_lshrrev_b32 v18, 16, v18
    v_mul_u32_u24 v19, 21, v18
    v_sub_u32 v17, v17, v19
    v_and_b32 v19, 8, v18
    v_and_b32 v20, 1, v18
    v_lshl_add_u32 v19, v20, 2, v19
    v_bfe_u32 v20, v18, 1, 2
    v_add_u32 v19, v19, v20
    v_mul_u32_u24 v19, 2688, v19
    v_lshl_add_u32 v19, v17, 4, v19
    v_add_u32 v8, s11, v19
    s_add_u32 m0, s13, 0
    s_nop 0
    buffer_load_dwordx4 v8, s[44:47], s10 offen lds
    v_add_u32 v17, 64, v1
    v_mul_u32_u24 v18, 3121, v17
    v_lshrrev_b32 v18, 16, v18
    v_mul_u32_u24 v19, 21, v18
    v_sub_u32 v17, v17, v19
    v_and_b32 v19, 8, v18
    v_and_b32 v20, 1, v18
    v_lshl_add_u32 v19, v20, 2, v19
    v_bfe_u32 v20, v18, 1, 2
    v_add_u32 v19, v19, v20
    v_mul_u32_u24 v19, 2688, v19
    v_lshl_add_u32 v19, v17, 4, v19
    v_add_u32 v9, s11, v19
    s_add_u32 m0, s13, 1024
    s_nop 0
    buffer_load_dwordx4 v9, s[44:47], s10 offen lds
    v_add_u32 v17, 128, v1
    v_mul_u32_u24 v18, 3121, v17
    v_lshrrev_b32 v18, 16, v18
    v_mul_u32_u24 v19, 21, v18
    v_sub_u32 v17, v17, v19
    v_and_b32 v19, 8, v18
    v_and_b32 v20, 1, v18
    v_lshl_add_u32 v19, v20, 2, v19
    v_bfe_u32 v20, v18, 1, 2
    v_add_u32 v19, v19, v20
    v_mul_u32_u24 v19, 2688, v19
    v_lshl_add_u32 v19, v17, 4, v19
    v_add_u32 v10, s11, v19
    s_add_u32 m0, s13, 2048
    s_nop 0
    buffer_load_dwordx4 v10, s[44:47], s10 offen lds
    v_add_u32 v17, 192, v1
    v_mul_u32_u24 v18, 3121, v17
    v_lshrrev_b32 v18, 16, v18
    v_mul_u32_u24 v19, 21, v18
    v_sub_u32 v17, v17, v19
    v_and_b32 v19, 8, v18
    v_and_b32 v20, 1, v18
    v_lshl_add_u32 v19, v20, 2, v19
    v_bfe_u32 v20, v18, 1, 2
    v_add_u32 v19, v19, v20
    v_mul_u32_u24 v19, 2688, v19
    v_lshl_add_u32 v19, v17, 4, v19
    v_add_u32 v11, s11, v19
    s_add_u32 m0, s13, 3072
    s_nop 0
    buffer_load_dwordx4 v11, s[44:47], s10 offen lds
    v_add_u32 v17, 256, v1
    v_mul_u32_u24 v18, 3121, v17
    v_lshrrev_b32 v18, 16, v18
    v_mul_u32_u24 v19, 21, v18
    v_sub_u32 v17, v17, v19
    v_and_b32 v19, 8, v18
    v_and_b32 v20, 1, v18
    v_lshl_add_u32 v19, v20, 2, v19
    v_bfe_u32 v20, v18, 1, 2
    v_add_u32 v19, v19, v20
    v_mul_u32_u24 v19, 2688, v19
    v_lshl_add_u32 v19, v17, 4, v19
    v_add_u32 v12, s11, v19
    s_add_u32 m0, s13, 4096
    s_nop 0
    buffer_load_dwordx4 v12, s[44:47], s10 offen lds
    v_add_u32 v17, 320, v1
    v_mul_u32_u24 v18, 3121, v17
    v_lshrrev_b32 v18, 16, v18
    v_mul_u32_u24 v19, 21, v18
    v_sub_u32 v17, v17, v19
    v_and_b32 v19, 8, v18
    v_and_b32 v20, 1, v18
    v_lshl_add_u32 v19, v20, 2, v19
    v_bfe_u32 v20, v18, 1, 2
    v_add_u32 v19, v19, v20
    v_mul_u32_u24 v19, 2688, v19
    v_lshl_add_u32 v19, v17, 4, v19
    v_add_u32 v13, s11, v19
    s_add_u32 m0, s13, 5120
    s_mov_b64 exec, 0xffff
    buffer_load_dwordx4 v13, s[44:47], s10 offen lds
    s_mov_b64 exec, -1
    s_add_u32 s8, s8, 1
    s_cmp_eq_u32 s8, 7
    s_cselect_b32 s8, 0, s8
    s_lshl_b32 s9, s8, 7
    s_mul_i32 s10, s8, 172032
    s_add_u32 m0, s12, 37888
    s_nop 0
    buffer_load_dwordx4 v4, s[40:43], s9 offen lds
    s_add_u32 m0, s12, 38912
    s_nop 0
    buffer_load_dwordx4 v5, s[40:43], s9 offen lds
    s_add_u32 m0, s12, 39936
    s_nop 0
    buffer_load_dwordx4 v6, s[40:43], s9 offen lds
    s_add_u32 m0, s12, 40960
    s_nop 0
    buffer_load_dwordx4 v7, s[40:43], s9 offen lds
    s_add_u32 m0, s13, 37888
    s_nop 0
    buffer_load_dwordx4 v8, s[44:47], s10 offen lds
    s_add_u32 m0, s13, 38912
    s_nop 0
    buffer_load_dwordx4 v9, s[44:47], s10 offen lds
    s_add_u32 m0, s13, 39936
    s_nop 0
    buffer_load_dwordx4 v10, s[44:47], s10 offen lds
    s_add_u32 m0, s13, 40960
    s_nop 0
    buffer_load_dwordx4 v11, s[44:47], s10 offen lds
    s_add_u32 m0, s13, 41984
    s_nop 0
    buffer_load_dwordx4 v12, s[44:47], s10 offen lds
    s_add_u32 m0, s13, 43008
    s_mov_b64 exec, 0xffff
    buffer_load_dwordx4 v13, s[44:47], s10 offen lds
    s_mov_b64 exec, -1
    s_lshr_b32 s98, s4, 1
    s_and_b32 s96, s4, 1
    s_lshl_b32 s96, s96, 3
    s_and_b32 s14, s5, 7
    s_add_u32 s96, s96, s14
    s_lshr_b32 s97, s5, 3
    s_lshl_b32 s99, s4, 1
    s_lshr_b32 s14, s5, 4
    s_add_u32 s99, s99, s14
    s_and_b32 s100, s5, 15
    s_mul_i32 s14, s5, 37
    s_lshr_b32 s14, s14, 8
    s_mul_i32 s15, s14, 7
    s_sub_u32 s63, s5, s15
    s_min_u32 s14, s14, 3
    s_lshl_b32 s101, s4, 2
    s_add_u32 s101, s101, s14
    s_lshl_b32 s15, s96, 7
    s_lshl_b32 s14, s3, 5
    s_add_u32 s15, s15, s14
    v_lshrrev_b32 v17, 3, v1
    v_add_u32 v17, s15, v17
    v_mul_u32_u24 v17, 4096, v17
    v_and_b32 v18, 7, v1
    v_lshrrev_b32 v19, 4, v1
    v_xor_b32 v18, v18, v19
    v_lshl_add_u32 v24, v18, 4, v17
    v_xor_b32 v18, 4, v18
    v_lshl_add_u32 v25, v18, 4, v17
    v_add_u32 v25, 32768, v25
    v_add_u32 v26, 65536, v24
    v_add_u32 v27, 65536, v25
    s_cmp_lt_u32 s98, 2
    s_cselect_b32 s56, s24, s26
    s_cselect_b32 s57, s25, s27
    s_and_b32 s57, s57, 0xffff
    s_mov_b32 s58, 8388608
    s_mov_b32 s59, 0x20000
    v_lshlrev_b32 v28, 4, v1
    s_and_b32 s14, s98, 1
    s_lshl_b32 s7, s14, 11
    s_mul_i32 s6, s14, 229376
    s_lshr_b32 s15, s98, 1
    s_lshl_b32 s15, s15, 2
    s_add_u32 s15, s15, s97
    s_mul_i32 s15, s15, 458752
    s_add_u32 s6, s6, s15
    s_mul_i32 s15, s3, 3584
    s_add_u32 s6, s6, s15
    s_add_u32 s6, s6, 8388608
    s_add_u32 s61, s15, 16384
    s_lshl_b32 s60, s3, 12
    s_lshl_b32 s62, s3, 10
    s_and_b32 s11, s5, 7
    s_and_b32 s14, s97, 1
    s_lshl_b32 s14, s14, 2
    s_add_u32 s11, s11, s14
    s_cmp_lt_u32 s97, 2
    s_cselect_b32 s14, 2, 0
    s_add_u32 s11, s11, s14
    s_and_b32 s30, s4, 0
    s_lshl_b32 s30, s30, 3
    s_xor_b32 s31, s30, 8
    s_lshl_b32 s15, s96, 7
    s_lshl_b32 s14, s3, 5
    s_add_u32 s15, s15, s14
    v_lshrrev_b32 v17, 1, v1
    v_add_u32 v17, s15, v17
    v_lshlrev_b32 v17, 12, v17
    v_and_b32 v18, 1, v1
    v_add_u32 v18, s11, v18
    v_and_b32 v19, 7, v18
    v_lshl_add_u32 v36, v19, 7, v17
    v_add_u32 v18, 2, v18
    v_and_b32 v19, 7, v18
    v_lshl_add_u32 v37, v19, 7, v17
    s_add_u32 s14, s36, 393216
    s_addc_u32 s15, s37, 0
    s_load_dword s39, s[14:15], 0
    s_waitcnt lgkmcnt(0)
    s_mul_i32 s38, s39, 0x19660d
    s_add_u32 s38, s38, 0x3c6ef35f
    s_and_b32 s14, s38, 0xfff
    s_or_b32 s14, s14, 0x4000
    s_lshr_b32 s15, s39, 16
    s_cmp_eq_u32 s14, s15
    s_cselect_b32 s15, 0x1000, 0
    s_or_b32 s14, s14, s15
    s_lshl_b32 s35, s14, 16
    s_mov_b32 s48, s36
    s_and_b32 s49, s37, 0xffff
    s_mov_b32 s50, 25165824
    s_mov_b32 s51, 0x20000
    s_mov_b32 s52, s32
    s_and_b32 s53, s33, 0xffff
    s_mov_b32 s54, 3670016
    s_mov_b32 s55, 0x20000
    s_waitcnt vmcnt(10)
    s_barrier
    s_add_u32 s8, s8, 1
    s_cmp_eq_u32 s8, 7
    s_cselect_b32 s8, 0, s8
    s_lshl_b32 s9, s8, 7
    s_mul_i32 s10, s8, 172032
    s_add_u32 m0, s12, 75776
    s_nop 0
    buffer_load_dwordx4 v4, s[40:43], s9 offen lds
    s_add_u32 m0, s12, 76800
    s_nop 0
    buffer_load_dwordx4 v5, s[40:43], s9 offen lds
    s_add_u32 m0, s12, 77824
    s_nop 0
    buffer_load_dwordx4 v6, s[40:43], s9 offen lds
    s_add_u32 m0, s12, 78848
    s_nop 0
    buffer_load_dwordx4 v7, s[40:43], s9 offen lds
    s_add_u32 m0, s13, 75776
    s_nop 0
    buffer_load_dwordx4 v8, s[44:47], s10 offen lds
    s_add_u32 m0, s13, 76800
    s_nop 0
    buffer_load_dwordx4 v9, s[44:47], s10 offen lds
    s_add_u32 m0, s13, 77824
    s_nop 0
    buffer_load_dwordx4 v10, s[44:47], s10 offen lds
    s_add_u32 m0, s13, 78848
    s_nop 0
    buffer_load_dwordx4 v11, s[44:47], s10 offen lds
    s_add_u32 m0, s13, 79872
    s_nop 0
    buffer_load_dwordx4 v12, s[44:47], s10 offen lds
    s_add_u32 m0, s13, 80896
    s_mov_b64 exec, 0xffff
    buffer_load_dwordx4 v13, s[44:47], s10 offen lds
    s_mov_b64 exec, -1
    s_add_u32 s8, s8, 1
    s_cmp_eq_u32 s8, 7
    s_cselect_b32 s8, 0, s8
    s_lshl_b32 s9, s8, 7
    s_mul_i32 s10, s8, 172032
    s_add_u32 m0, s12, 113664
    s_nop 0
    buffer_load_dwordx4 v4, s[40:43], s9 offen lds
    s_add_u32 m0, s12, 114688
    s_nop 0
    buffer_load_dwordx4 v5, s[40:43], s9 offen lds
    s_waitcnt vmcnt(12)
    s_barrier
    s_add_u32 m0, s12, 115712
    s_nop 0
    buffer_load_dwordx4 v6, s[40:43], s9 offen lds
    s_add_u32 m0, s12, 116736
    s_nop 0
    buffer_load_dwordx4 v7, s[40:43], s9 offen lds
    s_add_u32 m0, s13, 113664
    s_nop 0
    buffer_load_dwordx4 v8, s[44:47], s10 offen lds
    s_add_u32 m0, s13, 114688
    s_nop 0
    buffer_load_dwordx4 v9, s[44:47], s10 offen lds
    s_add_u32 m0, s13, 115712
    s_nop 0
    buffer_load_dwordx4 v10, s[44:47], s10 offen lds
    s_add_u32 m0, s13, 116736
    s_nop 0
    buffer_load_dwordx4 v11, s[44:47], s10 offen lds
    s_add_u32 m0, s13, 117760
    s_nop 0
    buffer_load_dwordx4 v12, s[44:47], s10 offen lds
    s_add_u32 m0, s13, 118784
    s_mov_b64 exec, 0xffff
    buffer_load_dwordx4 v13, s[44:47], s10 offen lds
    s_mov_b64 exec, -1
    s_waitcnt vmcnt(10)
    s_barrier
    s_add_u32 s8, s8, 1
    s_cmp_eq_u32 s8, 7
    s_cselect_b32 s8, 0, s8
    s_lshl_b32 s9, s8, 7
    s_mul_i32 s10, s8, 172032
    s_add_u32 m0, s12, 0
    s_nop 0
    buffer_load_dwordx4 v4, s[40:43], s9 offen lds
    s_add_u32 m0, s12, 1024
    s_nop 0
    buffer_load_dwordx4 v5, s[40:43], s9 offen lds
    s_add_u32 m0, s12, 2048
    s_nop 0
    buffer_load_dwordx4 v6, s[40:43], s9 offen lds
    s_add_u32 m0, s12, 3072
    s_nop 0
    buffer_load_dwordx4 v7, s[40:43], s9 offen lds
    s_add_u32 m0, s13, 0
    s_nop 0
    buffer_load_dwordx4 v8, s[44:47], s10 offen lds
    s_add_u32 m0, s13, 1024
    s_nop 0
    buffer_load_dwordx4 v9, s[44:47], s10 offen lds
    s_add_u32 m0, s13, 2048
    s_nop 0
    buffer_load_dwordx4 v10, s[44:47], s10 offen lds
    s_add_u32 m0, s13, 3072
    s_nop 0
    buffer_load_dwordx4 v11, s[44:47], s10 offen lds
    s_add_u32 m0, s13, 4096
    s_nop 0
    buffer_load_dwordx4 v12, s[44:47], s10 offen lds
    s_add_u32 m0, s13, 5120
    s_mov_b64 exec, 0xffff
    buffer_load_dwordx4 v13, s[44:47], s10 offen lds
    s_mov_b64 exec, -1
    s_waitcnt vmcnt(10)
    s_barrier
    s_add_u32 s8, s8, 1
    s_cmp_eq_u32 s8, 7
    s_cselect_b32 s8, 0, s8
    s_lshl_b32 s9, s8, 7
    s_mul_i32 s10, s8, 172032
    s_add_u32 m0, s12, 37888
    s_nop 0
    buffer_load_dwordx4 v4, s[40:43], s9 offen lds
    s_add_u32 m0, s12, 38912
    s_nop 0
    buffer_load_dwordx4 v5, s[40:43], s9 offen lds
    s_add_u32 m0, s12, 39936
    s_nop 0
    buffer_load_dwordx4 v6, s[40:43], s9 offen lds
    s_add_u32 m0, s12, 40960
    s_nop 0
    buffer_load_dwordx4 v7, s[40:43], s9 offen lds
    s_add_u32 m0, s13, 37888
    s_nop 0
    buffer_load_dwordx4 v8, s[44:47], s10 offen lds
    s_add_u32 m0, s13, 38912
    s_nop 0
    buffer_load_dwordx4 v9, s[44:47], s10 offen lds
    s_add_u32 m0, s13, 39936
    s_nop 0
    buffer_load_dwordx4 v10, s[44:47], s10 offen lds
    s_add_u32 m0, s13, 40960
    s_nop 0
    buffer_load_dwordx4 v11, s[44:47], s10 offen lds
    s_add_u32 m0, s13, 41984
    s_nop 0
    buffer_load_dwordx4 v12, s[44:47], s10 offen lds
    s_add_u32 m0, s13, 43008
    s_mov_b64 exec, 0xffff
    buffer_load_dwordx4 v13, s[44:47], s10 offen lds
    s_mov_b64 exec, -1
    s_waitcnt vmcnt(10)
    s_barrier
    s_add_u32 s8, s8, 1
    s_cmp_eq_u32 s8, 7
    s_cselect_b32 s8, 0, s8
    s_lshl_b32 s9, s8, 7
    s_mul_i32 s10, s8, 172032
    s_add_u32 m0, s12, 75776
    s_nop 0
    buffer_load_dwordx4 v4, s[40:43], s9 offen lds
    s_add_u32 m0, s12, 76800
    s_nop 0
    buffer_load_dwordx4 v5, s[40:43], s9 offen lds
    s_add_u32 m0, s12, 77824
    s_nop 0
    buffer_load_dwordx4 v6, s[40:43], s9 offen lds
    s_add_u32 m0, s12, 78848
    s_nop 0
    buffer_load_dwordx4 v7, s[40:43], s9 offen lds
    s_add_u32 m0, s13, 75776
    s_nop 0
    buffer_load_dwordx4 v8, s[44:47], s10 offen lds
    s_add_u32 m0, s13, 76800
    s_nop 0
    buffer_load_dwordx4 v9, s[44:47], s10 offen lds
    s_add_u32 m0, s13, 77824
    s_nop 0
    buffer_load_dwordx4 v10, s[44:47], s10 offen lds
    s_add_u32 m0, s13, 78848
    s_nop 0
    buffer_load_dwordx4 v11, s[44:47], s10 offen lds
    s_add_u32 m0, s13, 79872
    s_nop 0
    buffer_load_dwordx4 v12, s[44:47], s10 offen lds
    s_add_u32 m0, s13, 80896
    s_mov_b64 exec, 0xffff
    buffer_load_dwordx4 v13, s[44:47], s10 offen lds
    s_mov_b64 exec, -1
    s_waitcnt vmcnt(10)
    s_barrier
    s_waitcnt vmcnt(0)
    s_barrier
    v_and_b32 v17, 31, v1
    v_lshlrev_b32 v30, 4, v17
    s_lshl_b32 s13, s101, 9
    s_add_u32 s13, s13, 131072
    v_lshrrev_b32 v17, 3, v1
    v_mul_u32_u24 v17, 896, v17
    v_and_b32 v18, 7, v1
    v_bfe_u32 v19, v1, 4, 1
    v_lshlrev_b32 v19, 1, v19
    v_xor_b32 v18, v18, v19
    v_lshl_add_u32 v33, v18, 4, v17
    v_xor_b32 v18, 4, v18
    v_lshl_add_u32 v34, v18, 4, v17
    v_mov_b32 v19, 0x7ffffff0
    v_cmp_gt_u32 vcc, 32, v1
    s_mul_i32 s9, s3, 25088
    s_lshl_b32 s14, s63, 7
    v_cndmask_b32 v35, v19, v34, vcc
    s_add_u32 s9, s9, s14
    s_mov_b32 s44, s20
    s_and_b32 s45, s21, 0xffff
    s_mov_b32 s46, 401408
    s_mov_b32 s47, 0x20000
    s_add_u32 s14, s99, 0
    s_mul_i32 s15, s14, 43
    s_lshr_b32 s15, s15, 8
    s_mul_i32 s12, s15, 6
    s_sub_u32 s14, s14, s12
    s_cmp_ge_u32 s14, 3
    s_cselect_b32 s14, 1, 0
    s_lshl_b32 s15, s15, 6
    s_add_u32 s24, s15, s14
    s_add_u32 s14, s99, 16
    s_mul_i32 s15, s14, 43
    s_lshr_b32 s15, s15, 8
    s_mul_i32 s12, s15, 6
    s_sub_u32 s14, s14, s12
    s_cmp_ge_u32 s14, 3
    s_cselect_b32 s14, 1, 0
    s_lshl_b32 s15, s15, 6
    s_add_u32 s25, s15, s14
    s_add_u32 s14, s99, 32
    s_mul_i32 s15, s14, 43
    s_lshr_b32 s15, s15, 8
    s_mul_i32 s12, s15, 6
    s_sub_u32 s14, s14, s12
    s_cmp_ge_u32 s14, 3
    s_cselect_b32 s14, 1, 0
    s_lshl_b32 s15, s15, 6
    s_add_u32 s26, s15, s14
    v_mov_b32 v17, s26
    v_mov_b32 v18, s25
    v_cmp_gt_u32 vcc, 16, v1
    v_mov_b32 v19, s24
    s_nop 0
    v_cndmask_b32 v17, v17, v18, vcc
    v_cmp_gt_u32 vcc, 8, v1
    v_bfe_u32 v18, v1, 1, 2
    v_min_u32 v18, 2, v18
    v_cndmask_b32 v17, v17, v19, vcc
    v_sub_u32 v18, s100, v18
    v_max_i32 v18, 0, v18
    v_lshl_add_u32 v17, v18, 2, v17
    v_and_b32 v18, 1, v1
    v_lshl_add_u32 v17, v18, 1, v17
    v_lshlrev_b32 v29, 4, v17
    s_mov_b32 s12, 0
    v_lshrrev_b32 v17, 4, v1
    v_lshlrev_b32 v18, 2, v17
    v_sub_u32 v18, v1, v18
    v_and_b32 v18, 15, v18
    v_lshlrev_b32 v18, 4, v18
    v_lshl_add_u32 v32, v17, 8, v18
    s_lshl_b32 s8, s99, 17
    s_add_u32 s8, s8, 3145728
    s_lshl_b32 s10, s100, 3
    s_add_u32 s10, s10, s3
    s_sub_u32 s10, s10, 16
    s_lshr_b32 s15, s98, 1
    s_lshl_b32 s15, s15, 2
    s_add_u32 s15, s15, s97
    s_lshl_b32 s15, s15, 4
    s_and_b32 s14, s98, 1
    s_lshl_b32 s14, s14, 3
    s_add_u32 s15, s15, s14
    s_add_u32 s15, s15, 128
    s_lshl_b32 s34, s15, 6
    v_and_b32 v39, 31, v1
    v_lshlrev_b32 v39, 4, v39
    s_add_u32 s14, s11, 0
    s_and_b32 s14, s14, 7
    s_or_b32 s14, s14, s30
    s_lshl_b32 s0, s14, 7
    s_add_u32 s0, s0, s7
    s_add_u32 m0, s60, 131072
    s_nop 0
    buffer_load_dwordx4 v24, s[56:59], s0 offen lds
    s_add_u32 m0, s60, 132096
    s_nop 0
    buffer_load_dwordx4 v25, s[56:59], s0 offen lds
    s_add_u32 m0, s60, 133120
    s_nop 0
    buffer_load_dwordx4 v26, s[56:59], s0 offen lds
    s_add_u32 m0, s60, 134144
    s_nop 0
    buffer_load_dwordx4 v27, s[56:59], s0 offen lds
    s_add_u32 s14, s11, 1
    s_and_b32 s14, s14, 7
    s_or_b32 s14, s14, s30
    s_lshl_b32 s0, s14, 7
    s_add_u32 s0, s0, s7
    s_add_u32 m0, s60, 0
    s_nop 0
    buffer_load_dwordx4 v24, s[56:59], s0 offen lds
    s_add_u32 m0, s60, 1024
    s_nop 0
    buffer_load_dwordx4 v25, s[56:59], s0 offen lds
    s_add_u32 m0, s60, 2048
    s_nop 0
    buffer_load_dwordx4 v26, s[56:59], s0 offen lds
    s_add_u32 m0, s60, 3072
    s_nop 0
    buffer_load_dwordx4 v27, s[56:59], s0 offen lds
    s_barrier
    s_barrier
    buffer_load_dword v31, v39, s[48:51], s34 offen sc1
    s_waitcnt vmcnt(0)
    v_cmp_ne_u32 vcc, s38, v31
    s_cbranch_vccz pa_1
    s_mov_b32 s39, 0
pab_2:
    buffer_load_dword v31, v39, s[48:51], s34 offen sc1
    s_add_u32 s39, s39, 1
    s_waitcnt vmcnt(0)
    v_cmp_ne_u32 vcc, s38, v31
    s_cmp_ge_u32 s39, 20000
    s_cbranch_scc1 pab_2_x
    s_cbranch_vccz pab_2_x
    s_sleep 4
    s_branch pab_2
pab_2_x:
pa_1:
    s_add_u32 s14, s11, 0
    s_and_b32 s14, s14, 7
    s_or_b32 s14, s14, s30
    s_mul_i32 s1, s14, 14336
    s_add_u32 s1, s1, s6
    s_add_u32 m0, s61, 131072
    s_nop 0
    buffer_load_dwordx4 v28, s[48:51], s1 offen offset:0 sc1 lds
    s_add_u32 m0, s61, 131072
    s_nop 0
    buffer_load_dwordx4 v28, s[48:51], s1 offen offset:1024 sc1 lds
    s_add_u32 m0, s61, 131072
    s_nop 0
    buffer_load_dwordx4 v28, s[48:51], s1 offen offset:2048 sc1 lds
    s_add_u32 m0, s61, 131072
    s_mov_b32 exec_hi, 0
    buffer_load_dwordx4 v28, s[48:51], s1 offen offset:3072 sc1 lds
    s_mov_b32 exec_hi, -1
    s_add_u32 s14, s11, 1
    s_and_b32 s14, s14, 7
    s_or_b32 s14, s14, s30
    s_mul_i32 s1, s14, 14336
    s_add_u32 s1, s1, s6
    s_add_u32 m0, s61, 0
    s_nop 0
    buffer_load_dwordx4 v28, s[48:51], s1 offen offset:0 sc1 lds
    s_add_u32 m0, s61, 0
    s_nop 0
    buffer_load_dwordx4 v28, s[48:51], s1 offen offset:1024 sc1 lds
    s_add_u32 m0, s61, 0
    s_nop 0
    buffer_load_dwordx4 v28, s[48:51], s1 offen offset:2048 sc1 lds
    s_add_u32 m0, s61, 0
    s_mov_b32 exec_hi, 0
    buffer_load_dwordx4 v28, s[48:51], s1 offen offset:3072 sc1 lds
    s_mov_b32 exec_hi, -1
    s_add_u32 s14, s11, 2
    s_and_b32 s14, s14, 7
    s_or_b32 s14, s14, s30
    s_lshl_b32 s0, s14, 7
    s_add_u32 s0, s0, s7
    s_add_u32 m0, s60, 32768
    s_nop 0
    buffer_load_dwordx4 v24, s[56:59], s0 offen lds
    s_add_u32 m0, s60, 33792
    s_nop 0
    buffer_load_dwordx4 v25, s[56:59], s0 offen lds
    s_add_u32 m0, s60, 34816
    s_nop 0
    buffer_load_dwordx4 v26, s[56:59], s0 offen lds
    s_add_u32 m0, s60, 35840
    s_nop 0
    buffer_load_dwordx4 v27, s[56:59], s0 offen lds
    s_add_u32 s14, s11, 2
    s_and_b32 s14, s14, 7
    s_or_b32 s14, s14, s30
    s_mul_i32 s1, s14, 14336
    s_add_u32 s1, s1, s6
    s_add_u32 m0, s61, 32768
    s_nop 0
    buffer_load_dwordx4 v28, s[48:51], s1 offen offset:0 sc1 lds
    s_add_u32 m0, s61, 32768
    s_nop 0
    buffer_load_dwordx4 v28, s[48:51], s1 offen offset:1024 sc1 lds
    s_add_u32 m0, s61, 32768
    s_nop 0
    buffer_load_dwordx4 v28, s[48:51], s1 offen offset:2048 sc1 lds
    s_add_u32 m0, s61, 32768
    s_mov_b32 exec_hi, 0
    buffer_load_dwordx4 v28, s[48:51], s1 offen offset:3072 sc1 lds
    s_mov_b32 exec_hi, -1
    s_waitcnt vmcnt(12)
    s_barrier
    s_add_u32 s14, s11, 3
    s_and_b32 s14, s14, 7
    s_or_b32 s14, s14, s30
    s_lshl_b32 s0, s14, 7
    s_add_u32 s0, s0, s7
    s_add_u32 m0, s60, 65536
    s_nop 0
    buffer_load_dwordx4 v24, s[56:59], s0 offen lds
    s_add_u32 m0, s60, 66560
    s_nop 0
    buffer_load_dwordx4 v25, s[56:59], s0 offen lds
    s_add_u32 m0, s60, 67584
    s_nop 0
    buffer_load_dwordx4 v26, s[56:59], s0 offen lds
    s_add_u32 m0, s60, 68608
    s_nop 0
    buffer_load_dwordx4 v27, s[56:59], s0 offen lds
    s_waitcnt vmcnt(12)
    s_barrier
    s_add_u32 s14, s11, 3
    s_and_b32 s14, s14, 7
    s_or_b32 s14, s14, s30
    s_mul_i32 s1, s14, 14336
    s_add_u32 s1, s1, s6
    s_add_u32 m0, s61, 65536
    s_nop 0
    buffer_load_dwordx4 v28, s[48:51], s1 offen offset:0 sc1 lds
    s_add_u32 m0, s61, 65536
    s_nop 0
    buffer_load_dwordx4 v28, s[48:51], s1 offen offset:1024 sc1 lds
    s_add_u32 m0, s61, 65536
    s_nop 0
    buffer_load_dwordx4 v28, s[48:51], s1 offen offset:2048 sc1 lds
    s_add_u32 m0, s61, 65536
    s_mov_b32 exec_hi, 0
    buffer_load_dwordx4 v28, s[48:51], s1 offen offset:3072 sc1 lds
    s_mov_b32 exec_hi, -1
    s_add_u32 s14, s11, 4
    s_and_b32 s14, s14, 7
    s_or_b32 s14, s14, s30
    s_lshl_b32 s0, s14, 7
    s_add_u32 s0, s0, s7
    s_add_u32 m0, s60, 98304
    s_nop 0
    buffer_load_dwordx4 v24, s[56:59], s0 offen lds
    s_add_u32 m0, s60, 99328
    s_nop 0
    buffer_load_dwordx4 v25, s[56:59], s0 offen lds
    s_add_u32 m0, s60, 100352
    s_nop 0
    buffer_load_dwordx4 v26, s[56:59], s0 offen lds
    s_add_u32 m0, s60, 101376
    s_nop 0
    buffer_load_dwordx4 v27, s[56:59], s0 offen lds
    s_waitcnt vmcnt(12)
    s_barrier
    s_add_u32 s14, s11, 4
    s_and_b32 s14, s14, 7
    s_or_b32 s14, s14, s30
    s_mul_i32 s1, s14, 14336
    s_add_u32 s1, s1, s6
    s_add_u32 m0, s61, 98304
    s_nop 0
    buffer_load_dwordx4 v28, s[48:51], s1 offen offset:0 sc1 lds
    s_add_u32 m0, s61, 98304
    s_nop 0
    buffer_load_dwordx4 v28, s[48:51], s1 offen offset:1024 sc1 lds
    s_add_u32 m0, s61, 98304
    s_nop 0
    buffer_load_dwordx4 v28, s[48:51], s1 offen offset:2048 sc1 lds
    s_add_u32 m0, s61, 98304
    s_mov_b32 exec_hi, 0
    buffer_load_dwordx4 v28, s[48:51], s1 offen offset:3072 sc1 lds
    s_mov_b32 exec_hi, -1
    s_add_u32 s14, s11, 5
    s_and_b32 s14, s14, 7
    s_or_b32 s14, s14, s30
    s_lshl_b32 s0, s14, 7
    s_add_u32 s0, s0, s7
    s_add_u32 m0, s60, 131072
    s_nop 0
    buffer_load_dwordx4 v24, s[56:59], s0 offen lds
    s_add_u32 m0, s60, 132096
    s_nop 0
    buffer_load_dwordx4 v25, s[56:59], s0 offen lds
    s_add_u32 m0, s60, 133120
    s_nop 0
    buffer_load_dwordx4 v26, s[56:59], s0 offen lds
    s_add_u32 m0, s60, 134144
    s_nop 0
    buffer_load_dwordx4 v27, s[56:59], s0 offen lds
    s_waitcnt vmcnt(12)
    s_barrier
    buffer_load_dword v31, v29, s[48:51], s12 offen sc1
    s_add_u32 s14, s11, 5
    s_and_b32 s14, s14, 7
    s_or_b32 s14, s14, s30
    s_mul_i32 s1, s14, 14336
    s_add_u32 s1, s1, s6
    s_add_u32 m0, s61, 131072
    s_nop 0
    buffer_load_dwordx4 v28, s[48:51], s1 offen offset:0 sc1 lds
    s_add_u32 m0, s61, 131072
    s_nop 0
    buffer_load_dwordx4 v28, s[48:51], s1 offen offset:1024 sc1 lds
    s_add_u32 m0, s61, 131072
    s_nop 0
    buffer_load_dwordx4 v28, s[48:51], s1 offen offset:2048 sc1 lds
    s_add_u32 m0, s61, 131072
    s_mov_b32 exec_hi, 0
    buffer_load_dwordx4 v28, s[48:51], s1 offen offset:3072 sc1 lds
    s_mov_b32 exec_hi, -1
    s_add_u32 s14, s11, 6
    s_and_b32 s14, s14, 7
    s_or_b32 s14, s14, s30
    s_lshl_b32 s0, s14, 7
    s_add_u32 s0, s0, s7
    s_add_u32 m0, s60, 0
    s_nop 0
    buffer_load_dwordx4 v24, s[56:59], s0 offen lds
    s_add_u32 m0, s60, 1024
    s_nop 0
    buffer_load_dwordx4 v25, s[56:59], s0 offen lds
    s_add_u32 m0, s60, 2048
    s_nop 0
    buffer_load_dwordx4 v26, s[56:59], s0 offen lds
    s_add_u32 m0, s60, 3072
    s_nop 0
    buffer_load_dwordx4 v27, s[56:59], s0 offen lds
    s_waitcnt vmcnt(13)
    s_barrier
    s_waitcnt vmcnt(8)
    v_cmp_ne_u32 vcc, s38, v31
    s_cbranch_vccz pk_3
    s_mov_b32 s39, 0
pkb_4:
    buffer_load_dword v31, v29, s[48:51], s12 offen sc1
    s_add_u32 s39, s39, 1
    s_waitcnt vmcnt(0)
    v_cmp_ne_u32 vcc, s38, v31
    s_cmp_ge_u32 s39, 20000
    s_cbranch_scc1 pkb_4_x
    s_cbranch_vccz pkb_4_x
    s_sleep 4
    s_branch pkb_4
pkb_4_x:
pk_3:
    s_add_u32 s14, s11, 6
    s_and_b32 s14, s14, 7
    s_or_b32 s14, s14, s30
    s_mul_i32 s1, s14, 14336
    s_add_u32 s1, s1, s6
    s_add_u32 m0, s61, 0
    s_nop 0
    buffer_load_dwordx4 v28, s[48:51], s1 offen offset:0 sc1 lds
    s_add_u32 m0, s61, 0
    s_nop 0
    buffer_load_dwordx4 v28, s[48:51], s1 offen offset:1024 sc1 lds
    s_add_u32 m0, s61, 0
    s_nop 0
    buffer_load_dwordx4 v28, s[48:51], s1 offen offset:2048 sc1 lds
    s_add_u32 m0, s61, 0
    s_mov_b32 exec_hi, 0
    buffer_load_dwordx4 v28, s[48:51], s1 offen offset:3072 sc1 lds
    s_mov_b32 exec_hi, -1
    s_add_u32 s14, s11, 7
    s_and_b32 s14, s14, 7
    s_or_b32 s14, s14, s30
    s_lshl_b32 s0, s14, 7
    s_add_u32 s0, s0, s7
    s_add_u32 m0, s60, 32768
    s_nop 0
    buffer_load_dwordx4 v24, s[56:59], s0 offen lds
    s_add_u32 m0, s60, 33792
    s_nop 0
    buffer_load_dwordx4 v25, s[56:59], s0 offen lds
    s_add_u32 m0, s60, 34816
    s_nop 0
    buffer_load_dwordx4 v26, s[56:59], s0 offen lds
    s_add_u32 m0, s60, 35840
    s_nop 0
    buffer_load_dwordx4 v27, s[56:59], s0 offen lds
    s_waitcnt vmcnt(12)
    s_barrier
    s_add_u32 s14, s11, 7
    s_and_b32 s14, s14, 7
    s_or_b32 s14, s14, s30
    s_mul_i32 s1, s14, 14336
    s_add_u32 s1, s1, s6
    s_add_u32 m0, s61, 32768
    s_nop 0
    buffer_load_dwordx4 v28, s[48:51], s1 offen offset:0 sc1 lds
    s_add_u32 m0, s61, 32768
    s_nop 0
    buffer_load_dwordx4 v28, s[48:51], s1 offen offset:1024 sc1 lds
    s_add_u32 m0, s61, 32768
    s_nop 0
    buffer_load_dwordx4 v28, s[48:51], s1 offen offset:2048 sc1 lds
    s_add_u32 m0, s61, 32768
    s_mov_b32 exec_hi, 0
    buffer_load_dwordx4 v28, s[48:51], s1 offen offset:3072 sc1 lds
    s_mov_b32 exec_hi, -1
    s_add_u32 s14, s10, 0
    s_max_i32 s14, s14, 0
    s_lshl_b32 s14, s14, 10
    s_add_u32 s14, s14, s8
    s_add_u32 m0, s62, 65536
    s_nop 0
    buffer_load_dwordx4 v28, s[48:51], s14 offen sc1 lds
    s_add_u32 s14, s10, 4
    s_max_i32 s14, s14, 0
    s_lshl_b32 s14, s14, 10
    s_add_u32 s14, s14, s8
    s_add_u32 m0, s62, 69632
    s_nop 0
    buffer_load_dwordx4 v28, s[48:51], s14 offen sc1 lds
    s_add_u32 s14, s10, 8
    s_max_i32 s14, s14, 0
    s_lshl_b32 s14, s14, 10
    s_add_u32 s14, s14, s8
    s_add_u32 m0, s62, 73728
    s_nop 0
    buffer_load_dwordx4 v28, s[48:51], s14 offen sc1 lds
    s_add_u32 s14, s10, 12
    s_max_i32 s14, s14, 0
    s_lshl_b32 s14, s14, 10
    s_add_u32 s14, s14, s8
    s_add_u32 m0, s62, 77824
    s_nop 0
    buffer_load_dwordx4 v28, s[48:51], s14 offen sc1 lds
    s_waitcnt vmcnt(12)
    s_barrier
    s_add_u32 s14, s10, 16
    s_max_i32 s14, s14, 0
    s_lshl_b32 s14, s14, 10
    s_add_u32 s14, s14, s8
    s_add_u32 m0, s62, 81920
    s_nop 0
    buffer_load_dwordx4 v28, s[48:51], s14 offen sc1 lds
    s_add_u32 s14, s10, 20
    s_max_i32 s14, s14, 0
    s_lshl_b32 s14, s14, 10
    s_add_u32 s14, s14, s8
    s_add_u32 m0, s62, 86016
    s_nop 0
    buffer_load_dwordx4 v28, s[48:51], s14 offen sc1 lds
    s_add_u32 s14, s10, 0
    s_max_i32 s14, s14, 0
    s_lshl_b32 s14, s14, 10
    s_add_u32 s14, s14, s8
    s_add_u32 s14, s14, 2097152
    s_add_u32 m0, s62, 98304
    s_nop 0
    buffer_load_dwordx4 v32, s[48:51], s14 offen sc1 lds
    s_add_u32 s14, s10, 4
    s_max_i32 s14, s14, 0
    s_lshl_b32 s14, s14, 10
    s_add_u32 s14, s14, s8
    s_add_u32 s14, s14, 2097152
    s_add_u32 m0, s62, 102400
    s_nop 0
    buffer_load_dwordx4 v32, s[48:51], s14 offen sc1 lds
    s_add_u32 s14, s10, 8
    s_max_i32 s14, s14, 0
    s_lshl_b32 s14, s14, 10
    s_add_u32 s14, s14, s8
    s_add_u32 s14, s14, 2097152
    s_add_u32 m0, s62, 106496
    s_nop 0
    buffer_load_dwordx4 v32, s[48:51], s14 offen sc1 lds
    s_add_u32 s14, s10, 12
    s_max_i32 s14, s14, 0
    s_lshl_b32 s14, s14, 10
    s_add_u32 s14, s14, s8
    s_add_u32 s14, s14, 2097152
    s_add_u32 m0, s62, 110592
    s_nop 0
    buffer_load_dwordx4 v32, s[48:51], s14 offen sc1 lds
    s_add_u32 s14, s10, 16
    s_max_i32 s14, s14, 0
    s_lshl_b32 s14, s14, 10
    s_add_u32 s14, s14, s8
    s_add_u32 s14, s14, 2097152
    s_add_u32 m0, s62, 114688
    s_nop 0
    buffer_load_dwordx4 v32, s[48:51], s14 offen sc1 lds
    s_add_u32 s14, s10, 20
    s_max_i32 s14, s14, 0
    s_lshl_b32 s14, s14, 10
    s_add_u32 s14, s14, s8
    s_add_u32 s14, s14, 2097152
    s_add_u32 m0, s62, 118784
    s_nop 0
    buffer_load_dwordx4 v32, s[48:51], s14 offen sc1 lds
    s_waitcnt vmcnt(12)
    s_barrier
    s_waitcnt vmcnt(0)
    s_cmp_ge_u32 s100, 2
    s_cbranch_scc1 nopatch_5
    v_lshrrev_b32 v17, 4, v1
    v_lshlrev_b32 v17, 12, v17
    v_and_b32 v18, 15, v1
    v_lshl_add_u32 v17, v18, 4, v17
    v_add_u32 v17, s62, v17
    v_add_u32 v17, 65536, v17
    v_mov_b32 v18, 0xf14a
    s_cmp_eq_u32 s100, 0
    s_cselect_b32 exec_hi, -1, 0
    ds_write_b16 v17, v18 offset:776
    s_mov_b32 exec_hi, -1
    s_waitcnt lgkmcnt(0)
nopatch_5:
    s_barrier
    s_and_b32 s14, s11, 7
    s_add_u32 s14, s14, s31
    s_mul_i32 s14, s14, 14336
    s_add_u32 s14, s14, s6
    v_lshlrev_b32 v17, 7, v1
    s_mov_b64 exec, 0xfffffff
    buffer_load_dword v38, v17, s[48:51], s14 offen sc1
    s_lshl_b32 s14, s5, 2
    s_add_u32 s14, s14, s3
    s_mul_i32 s14, s14, 3200
    s_mov_b64 exec, 0x1ffffff
    v_add_u32 v17, s14, v17
    buffer_load_dword v38, v17, s[44:47], 0 offen
    s_mov_b64 exec, -1
    s_add_u32 s14, s11, 8
    s_and_b32 s14, s14, 7
    s_or_b32 s14, s14, s31
    s_lshl_b32 s0, s14, 7
    s_add_u32 s0, s0, s7
    s_add_u32 m0, s60, 131072
    s_nop 0
    buffer_load_dwordx4 v24, s[56:59], s0 offen lds
    s_add_u32 m0, s60, 132096
    s_nop 0
    buffer_load_dwordx4 v25, s[56:59], s0 offen lds
    s_add_u32 m0, s60, 133120
    s_nop 0
    buffer_load_dwordx4 v26, s[56:59], s0 offen lds
    s_add_u32 m0, s60, 134144
    s_nop 0
    buffer_load_dwordx4 v27, s[56:59], s0 offen lds
    s_add_u32 s14, s11, 8
    s_and_b32 s14, s14, 7
    s_or_b32 s14, s14, s31
    s_mul_i32 s1, s14, 14336
    s_add_u32 s1, s1, s6
    s_add_u32 m0, s61, 131072
    s_nop 0
    buffer_load_dwordx4 v28, s[48:51], s1 offen offset:0 sc1 lds
    s_add_u32 m0, s61, 131072
    s_nop 0
    buffer_load_dwordx4 v28, s[48:51], s1 offen offset:1024 sc1 lds
    s_add_u32 m0, s61, 131072
    s_nop 0
    buffer_load_dwordx4 v28, s[48:51], s1 offen offset:2048 sc1 lds
    s_add_u32 m0, s61, 131072
    s_mov_b32 exec_hi, 0
    buffer_load_dwordx4 v28, s[48:51], s1 offen offset:3072 sc1 lds
    s_mov_b32 exec_hi, -1
    s_add_u32 s14, s11, 9
    s_and_b32 s14, s14, 7
    s_or_b32 s14, s14, s31
    s_lshl_b32 s0, s14, 7
    s_add_u32 s0, s0, s7
    s_add_u32 m0, s60, 0
    s_nop 0
    buffer_load_dwordx4 v24, s[56:59], s0 offen lds
    s_add_u32 m0, s60, 1024
    s_nop 0
    buffer_load_dwordx4 v25, s[56:59], s0 offen lds
    s_add_u32 m0, s60, 2048
    s_nop 0
    buffer_load_dwordx4 v26, s[56:59], s0 offen lds
    s_add_u32 m0, s60, 3072
    s_nop 0
    buffer_load_dwordx4 v27, s[56:59], s0 offen lds
    s_add_u32 s14, s11, 9
    s_and_b32 s14, s14, 7
    s_or_b32 s14, s14, s31
    s_mul_i32 s1, s14, 14336
    s_add_u32 s1, s1, s6
    s_add_u32 m0, s61, 0
    s_nop 0
    buffer_load_dwordx4 v28, s[48:51], s1 offen offset:0 sc1 lds
    s_add_u32 m0, s61, 0
    s_nop 0
    buffer_load_dwordx4 v28, s[48:51], s1 offen offset:1024 sc1 lds
    s_add_u32 m0, s61, 0
    s_nop 0
    buffer_load_dwordx4 v28, s[48:51], s1 offen offset:2048 sc1 lds
    s_add_u32 m0, s61, 0
    s_mov_b32 exec_hi, 0
    buffer_load_dwordx4 v28, s[48:51], s1 offen offset:3072 sc1 lds
    s_mov_b32 exec_hi, -1
    s_add_u32 s14, s11, 10
    s_and_b32 s14, s14, 7
    s_or_b32 s14, s14, s31
    s_lshl_b32 s0, s14, 7
    s_add_u32 s0, s0, s7
    s_add_u32 m0, s60, 32768
    s_nop 0
    buffer_load_dwordx4 v24, s[56:59], s0 offen lds
    s_add_u32 m0, s60, 33792
    s_nop 0
    buffer_load_dwordx4 v25, s[56:59], s0 offen lds
    s_add_u32 m0, s60, 34816
    s_nop 0
    buffer_load_dwordx4 v26, s[56:59], s0 offen lds
    s_add_u32 m0, s60, 35840
    s_nop 0
    buffer_load_dwordx4 v27, s[56:59], s0 offen lds
    s_cmp_lg_u32 s2, 0
    s_cbranch_scc1 eb_done
    s_cmp_lg_u32 s3, 0
    s_cbranch_scc1 eb_done
    v_lshlrev_b32 v17, 6, v1
    s_mov_b32 s39, 0
eb_loop:
    s_mov_b32 s14, 0
    buffer_load_dword v40, v17, s[48:51], s14 offen sc1
    s_mov_b32 s14, 4096
    buffer_load_dword v41, v17, s[48:51], s14 offen sc1
    s_mov_b32 s14, 8192
    buffer_load_dword v42, v17, s[48:51], s14 offen sc1
    s_mov_b32 s14, 12288
    buffer_load_dword v43, v17, s[48:51], s14 offen sc1
    s_add_u32 s39, s39, 1
    s_waitcnt vmcnt(0)
    v_xor_b32 v40, s38, v40
    v_xor_b32 v41, s38, v41
    v_xor_b32 v42, s38, v42
    v_xor_b32 v43, s38, v43
    v_or_b32 v40, v40, v41
    v_or3_b32 v40, v40, v42, v43
    v_cmp_ne_u32 vcc, 0, v40
    s_cmp_ge_u32 s39, 20000
    s_cbranch_scc1 eb_st
    s_cbranch_vccnz eb_loop
eb_st:
    s_mov_b32 s14, 393216
    v_mov_b32 v17, 0
    v_mov_b32 v18, s38
    s_mov_b64 exec, 1
    buffer_store_dword v18, v17, s[48:51], s14 offen sc1
    s_mov_b64 exec, -1
eb_done:
    s_waitcnt vmcnt(12)
    s_barrier
    s_add_u32 s14, s11, 10
    s_and_b32 s14, s14, 7
    s_or_b32 s14, s14, s31
    s_mul_i32 s1, s14, 14336
    s_add_u32 s1, s1, s6
    s_add_u32 m0, s61, 32768
    s_nop 0
    buffer_load_dwordx4 v28, s[48:51], s1 offen offset:0 sc1 lds
    s_add_u32 m0, s61, 32768
    s_nop 0
    buffer_load_dwordx4 v28, s[48:51], s1 offen offset:1024 sc1 lds
    s_add_u32 m0, s61, 32768
    s_nop 0
    buffer_load_dwordx4 v28, s[48:51], s1 offen offset:2048 sc1 lds
    s_add_u32 m0, s61, 32768
    s_mov_b32 exec_hi, 0
    buffer_load_dwordx4 v28, s[48:51], s1 offen offset:3072 sc1 lds
    s_mov_b32 exec_hi, -1
    s_add_u32 s14, s11, 11
    s_and_b32 s14, s14, 7
    s_or_b32 s14, s14, s31
    s_lshl_b32 s0, s14, 7
    s_add_u32 s0, s0, s7
    s_add_u32 m0, s60, 65536
    s_nop 0
    buffer_load_dwordx4 v24, s[56:59], s0 offen lds
    s_add_u32 m0, s60, 66560
    s_nop 0
    buffer_load_dwordx4 v25, s[56:59], s0 offen lds
    s_add_u32 m0, s60, 67584
    s_nop 0
    buffer_load_dwordx4 v26, s[56:59], s0 offen lds
    s_add_u32 m0, s60, 68608
    s_nop 0
    buffer_load_dwordx4 v27, s[56:59], s0 offen lds
    s_waitcnt vmcnt(12)
    s_barrier
    s_add_u32 s14, s11, 11
    s_and_b32 s14, s14, 7
    s_or_b32 s14, s14, s31
    s_mul_i32 s1, s14, 14336
    s_add_u32 s1, s1, s6
    s_add_u32 m0, s61, 65536
    s_nop 0
    buffer_load_dwordx4 v28, s[48:51], s1 offen offset:0 sc1 lds
    s_add_u32 m0, s61, 65536
    s_nop 0
    buffer_load_dwordx4 v28, s[48:51], s1 offen offset:1024 sc1 lds
    s_add_u32 m0, s61, 65536
    s_nop 0
    buffer_load_dwordx4 v28, s[48:51], s1 offen offset:2048 sc1 lds
    s_add_u32 m0, s61, 65536
    s_mov_b32 exec_hi, 0
    buffer_load_dwordx4 v28, s[48:51], s1 offen offset:3072 sc1 lds
    s_mov_b32 exec_hi, -1
    s_add_u32 s14, s11, 12
    s_and_b32 s14, s14, 7
    s_or_b32 s14, s14, s31
    s_lshl_b32 s0, s14, 7
    s_add_u32 s0, s0, s7
    s_add_u32 m0, s60, 98304
    s_nop 0
    buffer_load_dwordx4 v24, s[56:59], s0 offen lds
    s_add_u32 m0, s60, 99328
    s_nop 0
    buffer_load_dwordx4 v25, s[56:59], s0 offen lds
    s_add_u32 m0, s60, 100352
    s_nop 0
    buffer_load_dwordx4 v26, s[56:59], s0 offen lds
    s_add_u32 m0, s60, 101376
    s_nop 0
    buffer_load_dwordx4 v27, s[56:59], s0 offen lds
    s_waitcnt vmcnt(12)
    s_barrier
    s_add_u32 s14, s11, 12
    s_and_b32 s14, s14, 7
    s_or_b32 s14, s14, s31
    s_mul_i32 s1, s14, 14336
    s_add_u32 s1, s1, s6
    s_add_u32 m0, s61, 98304
    s_nop 0
    buffer_load_dwordx4 v28, s[48:51], s1 offen offset:0 sc1 lds
    s_add_u32 m0, s61, 98304
    s_nop 0
    buffer_load_dwordx4 v28, s[48:51], s1 offen offset:1024 sc1 lds
    s_add_u32 m0, s61, 98304
    s_nop 0
    buffer_load_dwordx4 v28, s[48:51], s1 offen offset:2048 sc1 lds
    s_add_u32 m0, s61, 98304
    s_mov_b32 exec_hi, 0
    buffer_load_dwordx4 v28, s[48:51], s1 offen offset:3072 sc1 lds
    s_mov_b32 exec_hi, -1
    s_add_u32 s14, s11, 13
    s_and_b32 s14, s14, 7
    s_or_b32 s14, s14, s31
    s_lshl_b32 s0, s14, 7
    s_add_u32 s0, s0, s7
    s_add_u32 m0, s60, 131072
    s_nop 0
    buffer_load_dwordx4 v24, s[56:59], s0 offen lds
    s_add_u32 m0, s60, 132096
    s_nop 0
    buffer_load_dwordx4 v25, s[56:59], s0 offen lds
    s_add_u32 m0, s60, 133120
    s_nop 0
    buffer_load_dwordx4 v26, s[56:59], s0 offen lds
    s_add_u32 m0, s60, 134144
    s_nop 0
    buffer_load_dwordx4 v27, s[56:59], s0 offen lds
    s_waitcnt vmcnt(12)
    s_barrier
    s_add_u32 s14, s11, 13
    s_and_b32 s14, s14, 7
    s_or_b32 s14, s14, s31
    s_mul_i32 s1, s14, 14336
    s_add_u32 s1, s1, s6
    s_add_u32 m0, s61, 131072
    s_nop 0
    buffer_load_dwordx4 v28, s[48:51], s1 offen offset:0 sc1 lds
    s_add_u32 m0, s61, 131072
    s_nop 0
    buffer_load_dwordx4 v28, s[48:51], s1 offen offset:1024 sc1 lds
    s_add_u32 m0, s61, 131072
    s_nop 0
    buffer_load_dwordx4 v28, s[48:51], s1 offen offset:2048 sc1 lds
    s_add_u32 m0, s61, 131072
    s_mov_b32 exec_hi, 0
    buffer_load_dwordx4 v28, s[48:51], s1 offen offset:3072 sc1 lds
    s_mov_b32 exec_hi, -1
    s_add_u32 s14, s11, 14
    s_and_b32 s14, s14, 7
    s_or_b32 s14, s14, s31
    s_lshl_b32 s0, s14, 7
    s_add_u32 s0, s0, s7
    s_add_u32 m0, s60, 0
    s_nop 0
    buffer_load_dwordx4 v24, s[56:59], s0 offen lds
    s_add_u32 m0, s60, 1024
    s_nop 0
    buffer_load_dwordx4 v25, s[56:59], s0 offen lds
    s_add_u32 m0, s60, 2048
    s_nop 0
    buffer_load_dwordx4 v26, s[56:59], s0 offen lds
    s_add_u32 m0, s60, 3072
    s_nop 0
    buffer_load_dwordx4 v27, s[56:59], s0 offen lds
    s_waitcnt vmcnt(12)
    s_barrier
    s_add_u32 s14, s11, 14
    s_and_b32 s14, s14, 7
    s_or_b32 s14, s14, s31
    s_mul_i32 s1, s14, 14336
    s_add_u32 s1, s1, s6
    s_add_u32 m0, s61, 0
    s_nop 0
    buffer_load_dwordx4 v28, s[48:51], s1 offen offset:0 sc1 lds
    s_add_u32 m0, s61, 0
    s_nop 0
    buffer_load_dwordx4 v28, s[48:51], s1 offen offset:1024 sc1 lds
    s_add_u32 m0, s61, 0
    s_nop 0
    buffer_load_dwordx4 v28, s[48:51], s1 offen offset:2048 sc1 lds
    s_add_u32 m0, s61, 0
    s_mov_b32 exec_hi, 0
    buffer_load_dwordx4 v28, s[48:51], s1 offen offset:3072 sc1 lds
    s_mov_b32 exec_hi, -1
    s_add_u32 s14, s11, 15
    s_and_b32 s14, s14, 7
    s_or_b32 s14, s14, s31
    s_lshl_b32 s0, s14, 7
    s_add_u32 s0, s0, s7
    s_add_u32 m0, s60, 32768
    s_nop 0
    buffer_load_dwordx4 v24, s[56:59], s0 offen lds
    s_add_u32 m0, s60, 33792
    s_nop 0
    buffer_load_dwordx4 v25, s[56:59], s0 offen lds
    s_add_u32 m0, s60, 34816
    s_nop 0
    buffer_load_dwordx4 v26, s[56:59], s0 offen lds
    s_add_u32 m0, s60, 35840
    s_nop 0
    buffer_load_dwordx4 v27, s[56:59], s0 offen lds
    s_waitcnt vmcnt(12)
    s_barrier
    s_add_u32 s14, s11, 15
    s_and_b32 s14, s14, 7
    s_or_b32 s14, s14, s31
    s_mul_i32 s1, s14, 14336
    s_add_u32 s1, s1, s6
    s_add_u32 m0, s61, 32768
    s_nop 0
    buffer_load_dwordx4 v28, s[48:51], s1 offen offset:0 sc1 lds
    s_add_u32 m0, s61, 32768
    s_nop 0
    buffer_load_dwordx4 v28, s[48:51], s1 offen offset:1024 sc1 lds
    s_add_u32 m0, s61, 32768
    s_nop 0
    buffer_load_dwordx4 v28, s[48:51], s1 offen offset:2048 sc1 lds
    s_add_u32 m0, s61, 32768
    s_mov_b32 exec_hi, 0
    buffer_load_dwordx4 v28, s[48:51], s1 offen offset:3072 sc1 lds
    s_mov_b32 exec_hi, -1
    s_add_u32 s14, s9, 0
    s_add_u32 m0, s60, 65536
    s_nop 0
    buffer_load_dwordx4 v33, s[44:47], s14 offen lds
    s_add_u32 s14, s9, 7168
    s_add_u32 m0, s60, 66560
    s_nop 0
    buffer_load_dwordx4 v34, s[44:47], s14 offen lds
    s_add_u32 s14, s9, 14336
    s_add_u32 m0, s60, 67584
    s_nop 0
    buffer_load_dwordx4 v33, s[44:47], s14 offen lds
    s_add_u32 s14, s9, 21504
    s_add_u32 m0, s60, 68608
    s_nop 0
    buffer_load_dwordx4 v35, s[44:47], s14 offen lds
    s_waitcnt vmcnt(12)
    s_barrier
    buffer_load_dword v31, v30, s[48:51], s13 offen sc1
    s_add_u32 s14, s9, 100352
    s_add_u32 m0, s60, 81920
    s_nop 0
    buffer_load_dwordx4 v33, s[44:47], s14 offen lds
    s_add_u32 s14, s9, 107520
    s_add_u32 m0, s60, 82944
    s_nop 0
    buffer_load_dwordx4 v34, s[44:47], s14 offen lds
    s_add_u32 s14, s9, 114688
    s_add_u32 m0, s60, 83968
    s_nop 0
    buffer_load_dwordx4 v33, s[44:47], s14 offen lds
    s_add_u32 s14, s9, 121856
    s_add_u32 m0, s60, 84992
    s_nop 0
    buffer_load_dwordx4 v35, s[44:47], s14 offen lds
    s_add_u32 s14, s9, 200704
    s_add_u32 m0, s60, 98304
    s_nop 0
    buffer_load_dwordx4 v33, s[44:47], s14 offen lds
    s_add_u32 s14, s9, 207872
    s_add_u32 m0, s60, 99328
    s_nop 0
    buffer_load_dwordx4 v34, s[44:47], s14 offen lds
    s_add_u32 s14, s9, 215040
    s_add_u32 m0, s60, 100352
    s_nop 0
    buffer_load_dwordx4 v33, s[44:47], s14 offen lds
    s_add_u32 s14, s9, 222208
    s_add_u32 m0, s60, 101376
    s_nop 0
    buffer_load_dwordx4 v35, s[44:47], s14 offen lds
    s_waitcnt vmcnt(13)
    s_barrier
    s_waitcnt vmcnt(8)
    v_cmp_ne_u32 vcc, s38, v31
    s_cbranch_vccz po_6
    s_mov_b32 s39, 0
pob_7:
    buffer_load_dword v31, v30, s[48:51], s13 offen sc1
    s_add_u32 s39, s39, 1
    s_waitcnt vmcnt(0)
    v_cmp_ne_u32 vcc, s38, v31
    s_cmp_ge_u32 s39, 20000
    s_cbranch_scc1 pob_7_x
    s_cbranch_vccz pob_7_x
    s_sleep 4
    s_branch pob_7
pob_7_x:
po_6:
    s_add_u32 s14, s9, 301056
    s_add_u32 m0, s60, 114688
    s_nop 0
    buffer_load_dwordx4 v33, s[44:47], s14 offen lds
    s_add_u32 s14, s9, 308224
    s_add_u32 m0, s60, 115712
    s_nop 0
    buffer_load_dwordx4 v34, s[44:47], s14 offen lds
    s_add_u32 s14, s9, 315392
    s_add_u32 m0, s60, 116736
    s_nop 0
    buffer_load_dwordx4 v33, s[44:47], s14 offen lds
    s_add_u32 s14, s9, 322560
    s_add_u32 m0, s60, 117760
    s_nop 0
    buffer_load_dwordx4 v35, s[44:47], s14 offen lds
    s_barrier
    s_branch g1_join
g1_p1b:
    s_lshl_b32 s11, s6, 7
    s_lshl_b32 s14, s3, 5
    s_add_u32 s11, s11, s14
    v_lshrrev_b32 v17, 5, v1
    v_bfe_u32 v18, v1, 3, 2
    v_lshl_add_u32 v17, v17, 3, v18
    v_add_u32 v17, s11, v17
    v_mul_u32_u24 v17, 896, v17
    v_and_b32 v18, 7, v1
    v_lshrrev_b32 v19, 4, v1
    v_xor_b32 v18, v18, v19
    v_lshl_add_u32 v4, v18, 4, v17
    v_xor_b32 v18, 4, v18
    v_lshl_add_u32 v5, v18, 4, v17
    v_add_u32 v5, 14336, v5
    v_add_u32 v6, 3584, v4
    v_add_u32 v7, 3584, v5
    s_lshl_b32 s12, s3, 12
    s_lshl_b32 s9, s8, 7
    s_waitcnt lgkmcnt(0)
    s_mov_b32 s40, s22
    s_and_b32 s41, s23, 0xffff
    s_mov_b32 s42, 1835008
    s_mov_b32 s43, 0x20000
    s_add_u32 m0, s12, 65536
    s_nop 0
    buffer_load_dwordx4 v4, s[40:43], s9 offen lds
    s_add_u32 m0, s12, 66560
    s_nop 0
    buffer_load_dwordx4 v5, s[40:43], s9 offen lds
    s_add_u32 m0, s12, 67584
    s_nop 0
    buffer_load_dwordx4 v6, s[40:43], s9 offen lds
    s_add_u32 m0, s12, 68608
    s_nop 0
    buffer_load_dwordx4 v7, s[40:43], s9 offen lds
    s_cmp_lt_u32 s7, 4
    s_cselect_b32 s44, s28, s30
    s_cselect_b32 s45, s29, s31
    s_and_b32 s45, s45, 0xffff
    s_mov_b32 s46, 401408
    s_mov_b32 s47, 0x20000
    s_and_b32 s11, s7, 3
    s_mul_i32 s11, s11, 112
    s_mul_i32 s15, s3, 28
    s_mul_i32 s13, s3, 3584
    s_add_u32 s13, s13, 16384
    s_mul_i32 s10, s8, 128
    v_lshrrev_b32 v17, 3, v1
    v_add3_u32 v17, v17, s15, 0
    v_bfe_u32 v18, v17, 2, 2
    v_mul_u32_u24 v18, 28, v18
    v_lshrrev_b32 v19, 4, v17
    v_lshl_add_u32 v18, v19, 2, v18
    v_and_b32 v19, 3, v17
    v_add3_u32 v18, v18, v19, s11
    v_mul_u32_u24 v18, 896, v18
    v_bfe_u32 v19, v17, 1, 3
    v_and_b32 v20, 7, v1
    v_xor_b32 v19, v19, v20
    v_lshl_add_u32 v8, v19, 4, v18
    s_add_u32 m0, s13, 65536
    s_nop 0
    buffer_load_dwordx4 v8, s[44:47], s10 offen lds
    v_lshrrev_b32 v17, 3, v1
    v_add3_u32 v17, v17, s15, 8
    v_bfe_u32 v18, v17, 2, 2
    v_mul_u32_u24 v18, 28, v18
    v_lshrrev_b32 v19, 4, v17
    v_lshl_add_u32 v18, v19, 2, v18
    v_and_b32 v19, 3, v17
    v_add3_u32 v18, v18, v19, s11
    v_mul_u32_u24 v18, 896, v18
    v_bfe_u32 v19, v17, 1, 3
    v_and_b32 v20, 7, v1
    v_xor_b32 v19, v19, v20
    v_lshl_add_u32 v9, v19, 4, v18
    s_add_u32 m0, s13, 66560
    s_nop 0
    buffer_load_dwordx4 v9, s[44:47], s10 offen lds
    v_lshrrev_b32 v17, 3, v1
    v_add3_u32 v17, v17, s15, 16
    v_bfe_u32 v18, v17, 2, 2
    v_mul_u32_u24 v18, 28, v18
    v_lshrrev_b32 v19, 4, v17
    v_lshl_add_u32 v18, v19, 2, v18
    v_and_b32 v19, 3, v17
    v_add3_u32 v18, v18, v19, s11
    v_mul_u32_u24 v18, 896, v18
    v_bfe_u32 v19, v17, 1, 3
    v_and_b32 v20, 7, v1
    v_xor_b32 v19, v19, v20
    v_lshl_add_u32 v10, v19, 4, v18
    s_add_u32 m0, s13, 67584
    s_nop 0
    buffer_load_dwordx4 v10, s[44:47], s10 offen lds
    v_lshrrev_b32 v17, 3, v1
    v_add3_u32 v17, v17, s15, 24
    v_bfe_u32 v18, v17, 2, 2
    v_mul_u32_u24 v18, 28, v18
    v_lshrrev_b32 v19, 4, v17
    v_lshl_add_u32 v18, v19, 2, v18
    v_and_b32 v19, 3, v17
    v_add3_u32 v18, v18, v19, s11
    v_mul_u32_u24 v18, 896, v18
    v_bfe_u32 v19, v17, 1, 3
    v_and_b32 v20, 7, v1
    v_xor_b32 v19, v19, v20
    v_lshl_add_u32 v11, v19, 4, v18
    s_add_u32 m0, s13, 68608
    s_mov_b32 exec_hi, 0
    buffer_load_dwordx4 v11, s[44:47], s10 offen lds
    s_mov_b32 exec_hi, -1
    s_add_u32 s8, s8, 1
    s_cmp_eq_u32 s8, 7
    s_cselect_b32 s8, 0, s8
    s_lshl_b32 s9, s8, 7
    s_mul_i32 s10, s8, 128
    s_add_u32 m0, s12, 98304
    s_nop 0
    buffer_load_dwordx4 v4, s[40:43], s9 offen lds
    s_add_u32 m0, s12, 99328
    s_nop 0
    buffer_load_dwordx4 v5, s[40:43], s9 offen lds
    s_add_u32 m0, s12, 100352
    s_nop 0
    buffer_load_dwordx4 v6, s[40:43], s9 offen lds
    s_add_u32 m0, s12, 101376
    s_nop 0
    buffer_load_dwordx4 v7, s[40:43], s9 offen lds
    s_add_u32 m0, s13, 98304
    s_nop 0
    buffer_load_dwordx4 v8, s[44:47], s10 offen lds
    s_add_u32 m0, s13, 99328
    s_nop 0
    buffer_load_dwordx4 v9, s[44:47], s10 offen lds
    s_add_u32 m0, s13, 100352
    s_nop 0
    buffer_load_dwordx4 v10, s[44:47], s10 offen lds
    s_add_u32 m0, s13, 101376
    s_mov_b32 exec_hi, 0
    buffer_load_dwordx4 v11, s[44:47], s10 offen lds
    s_mov_b32 exec_hi, -1
    s_add_u32 s8, s8, 1
    s_cmp_eq_u32 s8, 7
    s_cselect_b32 s8, 0, s8
    s_lshl_b32 s9, s8, 7
    s_mul_i32 s10, s8, 128
    s_add_u32 m0, s12, 131072
    s_nop 0
    buffer_load_dwordx4 v4, s[40:43], s9 offen lds
    s_add_u32 m0, s12, 132096
    s_nop 0
    buffer_load_dwordx4 v5, s[40:43], s9 offen lds
    s_lshr_b32 s98, s4, 1
    s_and_b32 s96, s4, 1
    s_lshl_b32 s96, s96, 3
    s_and_b32 s14, s5, 7
    s_add_u32 s96, s96, s14
    s_lshr_b32 s97, s5, 3
    s_lshl_b32 s99, s4, 1
    s_lshr_b32 s14, s5, 4
    s_add_u32 s99, s99, s14
    s_and_b32 s100, s5, 15
    s_mul_i32 s14, s5, 37
    s_lshr_b32 s14, s14, 8
    s_mul_i32 s15, s14, 7
    s_sub_u32 s63, s5, s15
    s_min_u32 s14, s14, 3
    s_lshl_b32 s101, s4, 2
    s_add_u32 s101, s101, s14
    s_lshl_b32 s15, s96, 7
    s_lshl_b32 s14, s3, 5
    s_add_u32 s15, s15, s14
    v_lshrrev_b32 v17, 3, v1
    v_add_u32 v17, s15, v17
    v_mul_u32_u24 v17, 4096, v17
    v_and_b32 v18, 7, v1
    v_lshrrev_b32 v19, 4, v1
    v_xor_b32 v18, v18, v19
    v_lshl_add_u32 v24, v18, 4, v17
    v_xor_b32 v18, 4, v18
    v_lshl_add_u32 v25, v18, 4, v17
    v_add_u32 v25, 32768, v25
    v_add_u32 v26, 65536, v24
    v_add_u32 v27, 65536, v25
    s_cmp_lt_u32 s98, 2
    s_cselect_b32 s56, s24, s26
    s_cselect_b32 s57, s25, s27
    s_and_b32 s57, s57, 0xffff
    s_mov_b32 s58, 8388608
    s_mov_b32 s59, 0x20000
    v_lshlrev_b32 v28, 4, v1
    s_and_b32 s14, s98, 1
    s_lshl_b32 s7, s14, 11
    s_mul_i32 s6, s14, 229376
    s_lshr_b32 s15, s98, 1
    s_lshl_b32 s15, s15, 2
    s_add_u32 s15, s15, s97
    s_mul_i32 s15, s15, 458752
    s_add_u32 s6, s6, s15
    s_mul_i32 s15, s3, 3584
    s_add_u32 s6, s6, s15
    s_add_u32 s6, s6, 8388608
    s_add_u32 s61, s15, 16384
    s_lshl_b32 s60, s3, 12
    s_lshl_b32 s62, s3, 10
    s_and_b32 s11, s5, 7
    s_and_b32 s14, s97, 1
    s_lshl_b32 s14, s14, 2
    s_add_u32 s11, s11, s14
    s_cmp_lt_u32 s97, 2
    s_cselect_b32 s14, 2, 0
    s_add_u32 s11, s11, s14
    s_and_b32 s30, s4, 0
    s_lshl_b32 s30, s30, 3
    s_xor_b32 s31, s30, 8
    s_lshl_b32 s15, s96, 7
    s_lshl_b32 s14, s3, 5
    s_add_u32 s15, s15, s14
    v_lshrrev_b32 v17, 1, v1
    v_add_u32 v17, s15, v17
    v_lshlrev_b32 v17, 12, v17
    v_and_b32 v18, 1, v1
    v_add_u32 v18, s11, v18
    v_and_b32 v19, 7, v18
    v_lshl_add_u32 v36, v19, 7, v17
    v_add_u32 v18, 2, v18
    v_and_b32 v19, 7, v18
    v_lshl_add_u32 v37, v19, 7, v17
    s_add_u32 s14, s36, 393216
    s_addc_u32 s15, s37, 0
    s_load_dword s39, s[14:15], 0
    s_waitcnt lgkmcnt(0)
    s_mul_i32 s38, s39, 0x19660d
    s_add_u32 s38, s38, 0x3c6ef35f
    s_and_b32 s14, s38, 0xfff
    s_or_b32 s14, s14, 0x4000
    s_lshr_b32 s15, s39, 16
    s_cmp_eq_u32 s14, s15
    s_cselect_b32 s15, 0x1000, 0
    s_or_b32 s14, s14, s15
    s_lshl_b32 s35, s14, 16
    s_mov_b32 s48, s36
    s_and_b32 s49, s37, 0xffff
    s_mov_b32 s50, 25165824
    s_mov_b32 s51, 0x20000
    s_mov_b32 s52, s32
    s_and_b32 s53, s33, 0xffff
    s_mov_b32 s54, 3670016
    s_mov_b32 s55, 0x20000
    s_waitcnt vmcnt(10)
    s_barrier
    s_add_u32 m0, s12, 133120
    s_nop 0
    buffer_load_dwordx4 v6, s[40:43], s9 offen lds
    s_add_u32 m0, s12, 134144
    s_nop 0
    buffer_load_dwordx4 v7, s[40:43], s9 offen lds
    s_add_u32 m0, s13, 131072
    s_nop 0
    buffer_load_dwordx4 v8, s[44:47], s10 offen lds
    s_add_u32 m0, s13, 132096
    s_nop 0
    buffer_load_dwordx4 v9, s[44:47], s10 offen lds
    s_add_u32 m0, s13, 133120
    s_nop 0
    buffer_load_dwordx4 v10, s[44:47], s10 offen lds
    s_add_u32 m0, s13, 134144
    s_mov_b32 exec_hi, 0
    buffer_load_dwordx4 v11, s[44:47], s10 offen lds
    s_mov_b32 exec_hi, -1
    s_add_u32 s8, s8, 1
    s_cmp_eq_u32 s8, 7
    s_cselect_b32 s8, 0, s8
    s_lshl_b32 s9, s8, 7
    s_mul_i32 s10, s8, 128
    s_add_u32 m0, s12, 0
    s_nop 0
    buffer_load_dwordx4 v4, s[40:43], s9 offen lds
    s_add_u32 m0, s12, 1024
    s_nop 0
    buffer_load_dwordx4 v5, s[40:43], s9 offen lds
    s_add_u32 m0, s12, 2048
    s_nop 0
    buffer_load_dwordx4 v6, s[40:43], s9 offen lds
    s_add_u32 m0, s12, 3072
    s_nop 0
    buffer_load_dwordx4 v7, s[40:43], s9 offen lds
    s_waitcnt vmcnt(12)
    s_barrier
    s_add_u32 m0, s13, 0
    s_nop 0
    buffer_load_dwordx4 v8, s[44:47], s10 offen lds
    s_add_u32 m0, s13, 1024
    s_nop 0
    buffer_load_dwordx4 v9, s[44:47], s10 offen lds
    s_add_u32 m0, s13, 2048
    s_nop 0
    buffer_load_dwordx4 v10, s[44:47], s10 offen lds
    s_add_u32 m0, s13, 3072
    s_mov_b32 exec_hi, 0
    buffer_load_dwordx4 v11, s[44:47], s10 offen lds
    s_mov_b32 exec_hi, -1
    s_add_u32 s8, s8, 1
    s_cmp_eq_u32 s8, 7
    s_cselect_b32 s8, 0, s8
    s_lshl_b32 s9, s8, 7
    s_mul_i32 s10, s8, 128
    s_add_u32 m0, s12, 32768
    s_nop 0
    buffer_load_dwordx4 v4, s[40:43], s9 offen lds
    s_add_u32 m0, s12, 33792
    s_nop 0
    buffer_load_dwordx4 v5, s[40:43], s9 offen lds
    s_add_u32 m0, s12, 34816
    s_nop 0
    buffer_load_dwordx4 v6, s[40:43], s9 offen lds
    s_add_u32 m0, s12, 35840
    s_nop 0
    buffer_load_dwordx4 v7, s[40:43], s9 offen lds
    s_add_u32 m0, s13, 32768
    s_nop 0
    buffer_load_dwordx4 v8, s[44:47], s10 offen lds
    s_add_u32 m0, s13, 33792
    s_nop 0
    buffer_load_dwordx4 v9, s[44:47], s10 offen lds
    s_add_u32 m0, s13, 34816
    s_nop 0
    buffer_load_dwordx4 v10, s[44:47], s10 offen lds
    s_add_u32 m0, s13, 35840
    s_mov_b32 exec_hi, 0
    buffer_load_dwordx4 v11, s[44:47], s10 offen lds
    s_mov_b32 exec_hi, -1
    s_waitcnt vmcnt(16)
    s_barrier
    s_add_u32 s8, s8, 1
    s_cmp_eq_u32 s8, 7
    s_cselect_b32 s8, 0, s8
    s_lshl_b32 s9, s8, 7
    s_mul_i32 s10, s8, 128
    s_add_u32 m0, s12, 65536
    s_nop 0
    buffer_load_dwordx4 v4, s[40:43], s9 offen lds
    s_add_u32 m0, s12, 66560
    s_nop 0
    buffer_load_dwordx4 v5, s[40:43], s9 offen lds
    s_add_u32 m0, s12, 67584
    s_nop 0
    buffer_load_dwordx4 v6, s[40:43], s9 offen lds
    s_add_u32 m0, s12, 68608
    s_nop 0
    buffer_load_dwordx4 v7, s[40:43], s9 offen lds
    s_add_u32 m0, s13, 65536
    s_nop 0
    buffer_load_dwordx4 v8, s[44:47], s10 offen lds
    s_add_u32 m0, s13, 66560
    s_nop 0
    buffer_load_dwordx4 v9, s[44:47], s10 offen lds
    s_add_u32 m0, s13, 67584
    s_nop 0
    buffer_load_dwordx4 v10, s[44:47], s10 offen lds
    s_add_u32 m0, s13, 68608
    s_mov_b32 exec_hi, 0
    buffer_load_dwordx4 v11, s[44:47], s10 offen lds
    s_mov_b32 exec_hi, -1
    s_waitcnt vmcnt(16)
    s_barrier
    s_add_u32 s8, s8, 1
    s_cmp_eq_u32 s8, 7
    s_cselect_b32 s8, 0, s8
    s_lshl_b32 s9, s8, 7
    s_mul_i32 s10, s8, 128
    s_add_u32 m0, s12, 98304
    s_nop 0
    buffer_load_dwordx4 v4, s[40:43], s9 offen lds
    s_add_u32 m0, s12, 99328
    s_nop 0
    buffer_load_dwordx4 v5, s[40:43], s9 offen lds
    s_add_u32 m0, s12, 100352
    s_nop 0
    buffer_load_dwordx4 v6, s[40:43], s9 offen lds
    s_add_u32 m0, s12, 101376
    s_nop 0
    buffer_load_dwordx4 v7, s[40:43], s9 offen lds
    s_add_u32 m0, s13, 98304
    s_nop 0
    buffer_load_dwordx4 v8, s[44:47], s10 offen lds
    s_add_u32 m0, s13, 99328
    s_nop 0
    buffer_load_dwordx4 v9, s[44:47], s10 offen lds
    s_add_u32 m0, s13, 100352
    s_nop 0
    buffer_load_dwordx4 v10, s[44:47], s10 offen lds
    s_add_u32 m0, s13, 101376
    s_mov_b32 exec_hi, 0
    buffer_load_dwordx4 v11, s[44:47], s10 offen lds
    s_mov_b32 exec_hi, -1
    s_waitcnt vmcnt(16)
    s_barrier
    s_waitcnt vmcnt(8)
    s_barrier
    s_waitcnt vmcnt(0)
    s_barrier
    v_and_b32 v17, 31, v1
    v_lshlrev_b32 v30, 4, v17
    s_lshl_b32 s13, s101, 9
    s_add_u32 s13, s13, 131072
    v_lshrrev_b32 v17, 3, v1
    v_mul_u32_u24 v17, 896, v17
    v_and_b32 v18, 7, v1
    v_bfe_u32 v19, v1, 4, 1
    v_lshlrev_b32 v19, 1, v19
    v_xor_b32 v18, v18, v19
    v_lshl_add_u32 v33, v18, 4, v17
    v_xor_b32 v18, 4, v18
    v_lshl_add_u32 v34, v18, 4, v17
    v_mov_b32 v19, 0x7ffffff0
    v_cmp_gt_u32 vcc, 32, v1
    s_mul_i32 s9, s3, 25088
    s_lshl_b32 s14, s63, 7
    v_cndmask_b32 v35, v19, v34, vcc
    s_add_u32 s9, s9, s14
    s_mov_b32 s44, s20
    s_and_b32 s45, s21, 0xffff
    s_mov_b32 s46, 401408
    s_mov_b32 s47, 0x20000
    s_add_u32 s14, s99, 0
    s_mul_i32 s15, s14, 43
    s_lshr_b32 s15, s15, 8
    s_mul_i32 s12, s15, 6
    s_sub_u32 s14, s14, s12
    s_cmp_ge_u32 s14, 3
    s_cselect_b32 s14, 1, 0
    s_lshl_b32 s15, s15, 6
    s_add_u32 s24, s15, s14
    s_add_u32 s14, s99, 16
    s_mul_i32 s15, s14, 43
    s_lshr_b32 s15, s15, 8
    s_mul_i32 s12, s15, 6
    s_sub_u32 s14, s14, s12
    s_cmp_ge_u32 s14, 3
    s_cselect_b32 s14, 1, 0
    s_lshl_b32 s15, s15, 6
    s_add_u32 s25, s15, s14
    s_add_u32 s14, s99, 32
    s_mul_i32 s15, s14, 43
    s_lshr_b32 s15, s15, 8
    s_mul_i32 s12, s15, 6
    s_sub_u32 s14, s14, s12
    s_cmp_ge_u32 s14, 3
    s_cselect_b32 s14, 1, 0
    s_lshl_b32 s15, s15, 6
    s_add_u32 s26, s15, s14
    v_mov_b32 v17, s26
    v_mov_b32 v18, s25
    v_cmp_gt_u32 vcc, 16, v1
    v_mov_b32 v19, s24
    s_nop 0
    v_cndmask_b32 v17, v17, v18, vcc
    v_cmp_gt_u32 vcc, 8, v1
    v_bfe_u32 v18, v1, 1, 2
    v_min_u32 v18, 2, v18
    v_cndmask_b32 v17, v17, v19, vcc
    v_sub_u32 v18, s100, v18
    v_max_i32 v18, 0, v18
    v_lshl_add_u32 v17, v18, 2, v17
    v_and_b32 v18, 1, v1
    v_lshl_add_u32 v17, v18, 1, v17
    v_lshlrev_b32 v29, 4, v17
    s_mov_b32 s12, 0
    v_lshrrev_b32 v17, 4, v1
    v_lshlrev_b32 v18, 2, v17
    v_sub_u32 v18, v1, v18
    v_and_b32 v18, 15, v18
    v_lshlrev_b32 v18, 4, v18
    v_lshl_add_u32 v32, v17, 8, v18
    s_lshl_b32 s8, s99, 17
    s_add_u32 s8, s8, 3145728
    s_lshl_b32 s10, s100, 3
    s_add_u32 s10, s10, s3
    s_sub_u32 s10, s10, 16
    s_barrier
    s_barrier
    s_add_u32 s14, s11, 0
    s_and_b32 s14, s14, 7
    s_or_b32 s14, s14, s30
    s_lshl_b32 s0, s14, 7
    s_add_u32 s0, s0, s7
    s_add_u32 m0, s60, 131072
    s_nop 0
    buffer_load_dwordx4 v24, s[56:59], s0 offen lds
    s_add_u32 m0, s60, 132096
    s_nop 0
    buffer_load_dwordx4 v25, s[56:59], s0 offen lds
    s_add_u32 m0, s60, 133120
    s_nop 0
    buffer_load_dwordx4 v26, s[56:59], s0 offen lds
    s_add_u32 m0, s60, 134144
    s_nop 0
    buffer_load_dwordx4 v27, s[56:59], s0 offen lds
    s_add_u32 s14, s11, 1
    s_and_b32 s14, s14, 7
    s_or_b32 s14, s14, s30
    s_lshl_b32 s0, s14, 7
    s_add_u32 s0, s0, s7
    s_add_u32 m0, s60, 0
    s_nop 0
    buffer_load_dwordx4 v24, s[56:59], s0 offen lds
    s_add_u32 m0, s60, 1024
    s_nop 0
    buffer_load_dwordx4 v25, s[56:59], s0 offen lds
    s_add_u32 m0, s60, 2048
    s_nop 0
    buffer_load_dwordx4 v26, s[56:59], s0 offen lds
    s_add_u32 m0, s60, 3072
    s_nop 0
    buffer_load_dwordx4 v27, s[56:59], s0 offen lds
    s_barrier
    s_add_u32 s14, s11, 0
    s_and_b32 s14, s14, 7
    s_or_b32 s14, s14, s30
    s_mul_i32 s1, s14, 14336
    s_add_u32 s1, s1, s6
    s_add_u32 m0, s61, 131072
    s_nop 0
    buffer_load_dwordx4 v28, s[48:51], s1 offen offset:0 sc1 lds
    s_add_u32 m0, s61, 131072
    s_nop 0
    buffer_load_dwordx4 v28, s[48:51], s1 offen offset:1024 sc1 lds
    s_add_u32 m0, s61, 131072
    s_nop 0
    buffer_load_dwordx4 v28, s[48:51], s1 offen offset:2048 sc1 lds
    s_add_u32 m0, s61, 131072
    s_mov_b32 exec_hi, 0
    buffer_load_dwordx4 v28, s[48:51], s1 offen offset:3072 sc1 lds
    s_mov_b32 exec_hi, -1
    s_add_u32 s14, s11, 1
    s_and_b32 s14, s14, 7
    s_or_b32 s14, s14, s30
    s_mul_i32 s1, s14, 14336
    s_add_u32 s1, s1, s6
    s_add_u32 m0, s61, 0
    s_nop 0
    buffer_load_dwordx4 v28, s[48:51], s1 offen offset:0 sc1 lds
    s_add_u32 m0, s61, 0
    s_nop 0
    buffer_load_dwordx4 v28, s[48:51], s1 offen offset:1024 sc1 lds
    s_add_u32 m0, s61, 0
    s_nop 0
    buffer_load_dwordx4 v28, s[48:51], s1 offen offset:2048 sc1 lds
    s_add_u32 m0, s61, 0
    s_mov_b32 exec_hi, 0
    buffer_load_dwordx4 v28, s[48:51], s1 offen offset:3072 sc1 lds
    s_mov_b32 exec_hi, -1
    s_add_u32 s14, s11, 2
    s_and_b32 s14, s14, 7
    s_or_b32 s14, s14, s30
    s_lshl_b32 s0, s14, 7
    s_add_u32 s0, s0, s7
    s_add_u32 m0, s60, 32768
    s_nop 0
    buffer_load_dwordx4 v24, s[56:59], s0 offen lds
    s_add_u32 m0, s60, 33792
    s_nop 0
    buffer_load_dwordx4 v25, s[56:59], s0 offen lds
    s_add_u32 m0, s60, 34816
    s_nop 0
    buffer_load_dwordx4 v26, s[56:59], s0 offen lds
    s_add_u32 m0, s60, 35840
    s_nop 0
    buffer_load_dwordx4 v27, s[56:59], s0 offen lds
    s_add_u32 s14, s11, 2
    s_and_b32 s14, s14, 7
    s_or_b32 s14, s14, s30
    s_mul_i32 s1, s14, 14336
    s_add_u32 s1, s1, s6
    s_add_u32 m0, s61, 32768
    s_nop 0
    buffer_load_dwordx4 v28, s[48:51], s1 offen offset:0 sc1 lds
    s_add_u32 m0, s61, 32768
    s_nop 0
    buffer_load_dwordx4 v28, s[48:51], s1 offen offset:1024 sc1 lds
    s_add_u32 m0, s61, 32768
    s_nop 0
    buffer_load_dwordx4 v28, s[48:51], s1 offen offset:2048 sc1 lds
    s_add_u32 m0, s61, 32768
    s_mov_b32 exec_hi, 0
    buffer_load_dwordx4 v28, s[48:51], s1 offen offset:3072 sc1 lds
    s_mov_b32 exec_hi, -1
    s_waitcnt vmcnt(12)
    s_barrier
    s_add_u32 s14, s11, 3
    s_and_b32 s14, s14, 7
    s_or_b32 s14, s14, s30
    s_lshl_b32 s0, s14, 7
    s_add_u32 s0, s0, s7
    s_add_u32 m0, s60, 65536
    s_nop 0
    buffer_load_dwordx4 v24, s[56:59], s0 offen lds
    s_add_u32 m0, s60, 66560
    s_nop 0
    buffer_load_dwordx4 v25, s[56:59], s0 offen lds
    s_add_u32 m0, s60, 67584
    s_nop 0
    buffer_load_dwordx4 v26, s[56:59], s0 offen lds
    s_add_u32 m0, s60, 68608
    s_nop 0
    buffer_load_dwordx4 v27, s[56:59], s0 offen lds
    s_waitcnt vmcnt(12)
    s_barrier
    s_add_u32 s14, s11, 3
    s_and_b32 s14, s14, 7
    s_or_b32 s14, s14, s30
    s_mul_i32 s1, s14, 14336
    s_add_u32 s1, s1, s6
    s_add_u32 m0, s61, 65536
    s_nop 0
    buffer_load_dwordx4 v28, s[48:51], s1 offen offset:0 sc1 lds
    s_add_u32 m0, s61, 65536
    s_nop 0
    buffer_load_dwordx4 v28, s[48:51], s1 offen offset:1024 sc1 lds
    s_add_u32 m0, s61, 65536
    s_nop 0
    buffer_load_dwordx4 v28, s[48:51], s1 offen offset:2048 sc1 lds
    s_add_u32 m0, s61, 65536
    s_mov_b32 exec_hi, 0
    buffer_load_dwordx4 v28, s[48:51], s1 offen offset:3072 sc1 lds
    s_mov_b32 exec_hi, -1
    s_add_u32 s14, s11, 4
    s_and_b32 s14, s14, 7
    s_or_b32 s14, s14, s30
    s_lshl_b32 s0, s14, 7
    s_add_u32 s0, s0, s7
    s_add_u32 m0, s60, 98304
    s_nop 0
    buffer_load_dwordx4 v24, s[56:59], s0 offen lds
    s_add_u32 m0, s60, 99328
    s_nop 0
    buffer_load_dwordx4 v25, s[56:59], s0 offen lds
    s_add_u32 m0, s60, 100352
    s_nop 0
    buffer_load_dwordx4 v26, s[56:59], s0 offen lds
    s_add_u32 m0, s60, 101376
    s_nop 0
    buffer_load_dwordx4 v27, s[56:59], s0 offen lds
    s_waitcnt vmcnt(12)
    s_barrier
    s_add_u32 s14, s11, 4
    s_and_b32 s14, s14, 7
    s_or_b32 s14, s14, s30
    s_mul_i32 s1, s14, 14336
    s_add_u32 s1, s1, s6
    s_add_u32 m0, s61, 98304
    s_nop 0
    buffer_load_dwordx4 v28, s[48:51], s1 offen offset:0 sc1 lds
    s_add_u32 m0, s61, 98304
    s_nop 0
    buffer_load_dwordx4 v28, s[48:51], s1 offen offset:1024 sc1 lds
    s_add_u32 m0, s61, 98304
    s_nop 0
    buffer_load_dwordx4 v28, s[48:51], s1 offen offset:2048 sc1 lds
    s_add_u32 m0, s61, 98304
    s_mov_b32 exec_hi, 0
    buffer_load_dwordx4 v28, s[48:51], s1 offen offset:3072 sc1 lds
    s_mov_b32 exec_hi, -1
    s_add_u32 s14, s11, 5
    s_and_b32 s14, s14, 7
    s_or_b32 s14, s14, s30
    s_lshl_b32 s0, s14, 7
    s_add_u32 s0, s0, s7
    s_add_u32 m0, s60, 131072
    s_nop 0
    buffer_load_dwordx4 v24, s[56:59], s0 offen lds
    s_add_u32 m0, s60, 132096
    s_nop 0
    buffer_load_dwordx4 v25, s[56:59], s0 offen lds
    s_add_u32 m0, s60, 133120
    s_nop 0
    buffer_load_dwordx4 v26, s[56:59], s0 offen lds
    s_add_u32 m0, s60, 134144
    s_nop 0
    buffer_load_dwordx4 v27, s[56:59], s0 offen lds
    s_waitcnt vmcnt(12)
    s_barrier
    buffer_load_dword v31, v29, s[48:51], s12 offen sc1
    s_add_u32 s14, s11, 5
    s_and_b32 s14, s14, 7
    s_or_b32 s14, s14, s30
    s_mul_i32 s1, s14, 14336
    s_add_u32 s1, s1, s6
    s_add_u32 m0, s61, 131072
    s_nop 0
    buffer_load_dwordx4 v28, s[48:51], s1 offen offset:0 sc1 lds
    s_add_u32 m0, s61, 131072
    s_nop 0
    buffer_load_dwordx4 v28, s[48:51], s1 offen offset:1024 sc1 lds
    s_add_u32 m0, s61, 131072
    s_nop 0
    buffer_load_dwordx4 v28, s[48:51], s1 offen offset:2048 sc1 lds
    s_add_u32 m0, s61, 131072
    s_mov_b32 exec_hi, 0
    buffer_load_dwordx4 v28, s[48:51], s1 offen offset:3072 sc1 lds
    s_mov_b32 exec_hi, -1
    s_add_u32 s14, s11, 6
    s_and_b32 s14, s14, 7
    s_or_b32 s14, s14, s30
    s_lshl_b32 s0, s14, 7
    s_add_u32 s0, s0, s7
    s_add_u32 m0, s60, 0
    s_nop 0
    buffer_load_dwordx4 v24, s[56:59], s0 offen lds
    s_add_u32 m0, s60, 1024
    s_nop 0
    buffer_load_dwordx4 v25, s[56:59], s0 offen lds
    s_add_u32 m0, s60, 2048
    s_nop 0
    buffer_load_dwordx4 v26, s[56:59], s0 offen lds
    s_add_u32 m0, s60, 3072
    s_nop 0
    buffer_load_dwordx4 v27, s[56:59], s0 offen lds
    s_waitcnt vmcnt(13)
    s_barrier
    s_waitcnt vmcnt(8)
    v_cmp_ne_u32 vcc, s38, v31
    s_cbranch_vccz pk_8
    s_mov_b32 s39, 0
pkb_9:
    buffer_load_dword v31, v29, s[48:51], s12 offen sc1
    s_add_u32 s39, s39, 1
    s_waitcnt vmcnt(0)
    v_cmp_ne_u32 vcc, s38, v31
    s_cmp_ge_u32 s39, 20000
    s_cbranch_scc1 pkb_9_x
    s_cbranch_vccz pkb_9_x
    s_sleep 4
    s_branch pkb_9
pkb_9_x:
pk_8:
    s_add_u32 s14, s11, 6
    s_and_b32 s14, s14, 7
    s_or_b32 s14, s14, s30
    s_mul_i32 s1, s14, 14336
    s_add_u32 s1, s1, s6
    s_add_u32 m0, s61, 0
    s_nop 0
    buffer_load_dwordx4 v28, s[48:51], s1 offen offset:0 sc1 lds
    s_add_u32 m0, s61, 0
    s_nop 0
    buffer_load_dwordx4 v28, s[48:51], s1 offen offset:1024 sc1 lds
    s_add_u32 m0, s61, 0
    s_nop 0
    buffer_load_dwordx4 v28, s[48:51], s1 offen offset:2048 sc1 lds
    s_add_u32 m0, s61, 0
    s_mov_b32 exec_hi, 0
    buffer_load_dwordx4 v28, s[48:51], s1 offen offset:3072 sc1 lds
    s_mov_b32 exec_hi, -1
    s_add_u32 s14, s11, 7
    s_and_b32 s14, s14, 7
    s_or_b32 s14, s14, s30
    s_lshl_b32 s0, s14, 7
    s_add_u32 s0, s0, s7
    s_add_u32 m0, s60, 32768
    s_nop 0
    buffer_load_dwordx4 v24, s[56:59], s0 offen lds
    s_add_u32 m0, s60, 33792
    s_nop 0
    buffer_load_dwordx4 v25, s[56:59], s0 offen lds
    s_add_u32 m0, s60, 34816
    s_nop 0
    buffer_load_dwordx4 v26, s[56:59], s0 offen lds
    s_add_u32 m0, s60, 35840
    s_nop 0
    buffer_load_dwordx4 v27, s[56:59], s0 offen lds
    s_waitcnt vmcnt(12)
    s_barrier
    s_add_u32 s14, s11, 7
    s_and_b32 s14, s14, 7
    s_or_b32 s14, s14, s30
    s_mul_i32 s1, s14, 14336
    s_add_u32 s1, s1, s6
    s_add_u32 m0, s61, 32768
    s_nop 0
    buffer_load_dwordx4 v28, s[48:51], s1 offen offset:0 sc1 lds
    s_add_u32 m0, s61, 32768
    s_nop 0
    buffer_load_dwordx4 v28, s[48:51], s1 offen offset:1024 sc1 lds
    s_add_u32 m0, s61, 32768
    s_nop 0
    buffer_load_dwordx4 v28, s[48:51], s1 offen offset:2048 sc1 lds
    s_add_u32 m0, s61, 32768
    s_mov_b32 exec_hi, 0
    buffer_load_dwordx4 v28, s[48:51], s1 offen offset:3072 sc1 lds
    s_mov_b32 exec_hi, -1
    s_add_u32 s14, s10, 0
    s_max_i32 s14, s14, 0
    s_lshl_b32 s14, s14, 10
    s_add_u32 s14, s14, s8
    s_add_u32 m0, s62, 65536
    s_nop 0
    buffer_load_dwordx4 v28, s[48:51], s14 offen sc1 lds
    s_add_u32 s14, s10, 4
    s_max_i32 s14, s14, 0
    s_lshl_b32 s14, s14, 10
    s_add_u32 s14, s14, s8
    s_add_u32 m0, s62, 69632
    s_nop 0
    buffer_load_dwordx4 v28, s[48:51], s14 offen sc1 lds
    s_add_u32 s14, s10, 8
    s_max_i32 s14, s14, 0
    s_lshl_b32 s14, s14, 10
    s_add_u32 s14, s14, s8
    s_add_u32 m0, s62, 73728
    s_nop 0
    buffer_load_dwordx4 v28, s[48:51], s14 offen sc1 lds
    s_add_u32 s14, s10, 12
    s_max_i32 s14, s14, 0
    s_lshl_b32 s14, s14, 10
    s_add_u32 s14, s14, s8
    s_add_u32 m0, s62, 77824
    s_nop 0
    buffer_load_dwordx4 v28, s[48:51], s14 offen sc1 lds
    s_waitcnt vmcnt(12)
    s_barrier
    s_add_u32 s14, s10, 16
    s_max_i32 s14, s14, 0
    s_lshl_b32 s14, s14, 10
    s_add_u32 s14, s14, s8
    s_add_u32 m0, s62, 81920
    s_nop 0
    buffer_load_dwordx4 v28, s[48:51], s14 offen sc1 lds
    s_add_u32 s14, s10, 20
    s_max_i32 s14, s14, 0
    s_lshl_b32 s14, s14, 10
    s_add_u32 s14, s14, s8
    s_add_u32 m0, s62, 86016
    s_nop 0
    buffer_load_dwordx4 v28, s[48:51], s14 offen sc1 lds
    s_add_u32 s14, s10, 0
    s_max_i32 s14, s14, 0
    s_lshl_b32 s14, s14, 10
    s_add_u32 s14, s14, s8
    s_add_u32 s14, s14, 2097152
    s_add_u32 m0, s62, 98304
    s_nop 0
    buffer_load_dwordx4 v32, s[48:51], s14 offen sc1 lds
    s_add_u32 s14, s10, 4
    s_max_i32 s14, s14, 0
    s_lshl_b32 s14, s14, 10
    s_add_u32 s14, s14, s8
    s_add_u32 s14, s14, 2097152
    s_add_u32 m0, s62, 102400
    s_nop 0
    buffer_load_dwordx4 v32, s[48:51], s14 offen sc1 lds
    s_add_u32 s14, s10, 8
    s_max_i32 s14, s14, 0
    s_lshl_b32 s14, s14, 10
    s_add_u32 s14, s14, s8
    s_add_u32 s14, s14, 2097152
    s_add_u32 m0, s62, 106496
    s_nop 0
    buffer_load_dwordx4 v32, s[48:51], s14 offen sc1 lds
    s_add_u32 s14, s10, 12
    s_max_i32 s14, s14, 0
    s_lshl_b32 s14, s14, 10
    s_add_u32 s14, s14, s8
    s_add_u32 s14, s14, 2097152
    s_add_u32 m0, s62, 110592
    s_nop 0
    buffer_load_dwordx4 v32, s[48:51], s14 offen sc1 lds
    s_add_u32 s14, s10, 16
    s_max_i32 s14, s14, 0
    s_lshl_b32 s14, s14, 10
    s_add_u32 s14, s14, s8
    s_add_u32 s14, s14, 2097152
    s_add_u32 m0, s62, 114688
    s_nop 0
    buffer_load_dwordx4 v32, s[48:51], s14 offen sc1 lds
    s_add_u32 s14, s10, 20
    s_max_i32 s14, s14, 0
    s_lshl_b32 s14, s14, 10
    s_add_u32 s14, s14, s8
    s_add_u32 s14, s14, 2097152
    s_add_u32 m0, s62, 118784
    s_nop 0
    buffer_load_dwordx4 v32, s[48:51], s14 offen sc1 lds
    s_waitcnt vmcnt(12)
    s_barrier
    s_waitcnt vmcnt(0)
    s_cmp_ge_u32 s100, 2
    s_cbranch_scc1 nopatch_10
    v_lshrrev_b32 v17, 4, v1
    v_lshlrev_b32 v17, 12, v17
    v_and_b32 v18, 15, v1
    v_lshl_add_u32 v17, v18, 4, v17
    v_add_u32 v17, s62, v17
    v_add_u32 v17, 65536, v17
    v_mov_b32 v18, 0xf14a
    s_cmp_eq_u32 s100, 0
    s_cselect_b32 exec_hi, -1, 0
    ds_write_b16 v17, v18 offset:776
    s_mov_b32 exec_hi, -1
    s_waitcnt lgkmcnt(0)
nopatch_10:
    s_barrier
    s_and_b32 s14, s11, 7
    s_add_u32 s14, s14, s31
    s_mul_i32 s14, s14, 14336
    s_add_u32 s14, s14, s6
    v_lshlrev_b32 v17, 7, v1
    s_mov_b64 exec, 0xfffffff
    buffer_load_dword v38, v17, s[48:51], s14 offen sc1
    s_lshl_b32 s14, s5, 2
    s_add_u32 s14, s14, s3
    s_mul_i32 s14, s14, 3200
    s_mov_b64 exec, 0x1ffffff
    v_add_u32 v17, s14, v17
    buffer_load_dword v38, v17, s[44:47], 0 offen
    s_mov_b64 exec, -1
    s_add_u32 s14, s11, 8
    s_and_b32 s14, s14, 7
    s_or_b32 s14, s14, s31
    s_lshl_b32 s0, s14, 7
    s_add_u32 s0, s0, s7
    s_add_u32 m0, s60, 131072
    s_nop 0
    buffer_load_dwordx4 v24, s[56:59], s0 offen lds
    s_add_u32 m0, s60, 132096
    s_nop 0
    buffer_load_dwordx4 v25, s[56:59], s0 offen lds
    s_add_u32 m0, s60, 133120
    s_nop 0
    buffer_load_dwordx4 v26, s[56:59], s0 offen lds
    s_add_u32 m0, s60, 134144
    s_nop 0
    buffer_load_dwordx4 v27, s[56:59], s0 offen lds
    s_add_u32 s14, s11, 8
    s_and_b32 s14, s14, 7
    s_or_b32 s14, s14, s31
    s_mul_i32 s1, s14, 14336
    s_add_u32 s1, s1, s6
    s_add_u32 m0, s61, 131072
    s_nop 0
    buffer_load_dwordx4 v28, s[48:51], s1 offen offset:0 sc1 lds
    s_add_u32 m0, s61, 131072
    s_nop 0
    buffer_load_dwordx4 v28, s[48:51], s1 offen offset:1024 sc1 lds
    s_add_u32 m0, s61, 131072
    s_nop 0
    buffer_load_dwordx4 v28, s[48:51], s1 offen offset:2048 sc1 lds
    s_add_u32 m0, s61, 131072
    s_mov_b32 exec_hi, 0
    buffer_load_dwordx4 v28, s[48:51], s1 offen offset:3072 sc1 lds
    s_mov_b32 exec_hi, -1
    s_add_u32 s14, s11, 9
    s_and_b32 s14, s14, 7
    s_or_b32 s14, s14, s31
    s_lshl_b32 s0, s14, 7
    s_add_u32 s0, s0, s7
    s_add_u32 m0, s60, 0
    s_nop 0
    buffer_load_dwordx4 v24, s[56:59], s0 offen lds
    s_add_u32 m0, s60, 1024
    s_nop 0
    buffer_load_dwordx4 v25, s[56:59], s0 offen lds
    s_add_u32 m0, s60, 2048
    s_nop 0
    buffer_load_dwordx4 v26, s[56:59], s0 offen lds
    s_add_u32 m0, s60, 3072
    s_nop 0
    buffer_load_dwordx4 v27, s[56:59], s0 offen lds
    s_add_u32 s14, s11, 9
    s_and_b32 s14, s14, 7
    s_or_b32 s14, s14, s31
    s_mul_i32 s1, s14, 14336
    s_add_u32 s1, s1, s6
    s_add_u32 m0, s61, 0
    s_nop 0
    buffer_load_dwordx4 v28, s[48:51], s1 offen offset:0 sc1 lds
    s_add_u32 m0, s61, 0
    s_nop 0
    buffer_load_dwordx4 v28, s[48:51], s1 offen offset:1024 sc1 lds
    s_add_u32 m0, s61, 0
    s_nop 0
    buffer_load_dwordx4 v28, s[48:51], s1 offen offset:2048 sc1 lds
    s_add_u32 m0, s61, 0
    s_mov_b32 exec_hi, 0
    buffer_load_dwordx4 v28, s[48:51], s1 offen offset:3072 sc1 lds
    s_mov_b32 exec_hi, -1
    s_add_u32 s14, s11, 10
    s_and_b32 s14, s14, 7
    s_or_b32 s14, s14, s31
    s_lshl_b32 s0, s14, 7
    s_add_u32 s0, s0, s7
    s_add_u32 m0, s60, 32768
    s_nop 0
    buffer_load_dwordx4 v24, s[56:59], s0 offen lds
    s_add_u32 m0, s60, 33792
    s_nop 0
    buffer_load_dwordx4 v25, s[56:59], s0 offen lds
    s_add_u32 m0, s60, 34816
    s_nop 0
    buffer_load_dwordx4 v26, s[56:59], s0 offen lds
    s_add_u32 m0, s60, 35840
    s_nop 0
    buffer_load_dwordx4 v27, s[56:59], s0 offen lds
    s_waitcnt vmcnt(12)
    s_barrier
    s_add_u32 s14, s11, 10
    s_and_b32 s14, s14, 7
    s_or_b32 s14, s14, s31
    s_mul_i32 s1, s14, 14336
    s_add_u32 s1, s1, s6
    s_add_u32 m0, s61, 32768
    s_nop 0
    buffer_load_dwordx4 v28, s[48:51], s1 offen offset:0 sc1 lds
    s_add_u32 m0, s61, 32768
    s_nop 0
    buffer_load_dwordx4 v28, s[48:51], s1 offen offset:1024 sc1 lds
    s_add_u32 m0, s61, 32768
    s_nop 0
    buffer_load_dwordx4 v28, s[48:51], s1 offen offset:2048 sc1 lds
    s_add_u32 m0, s61, 32768
    s_mov_b32 exec_hi, 0
    buffer_load_dwordx4 v28, s[48:51], s1 offen offset:3072 sc1 lds
    s_mov_b32 exec_hi, -1
    s_add_u32 s14, s11, 11
    s_and_b32 s14, s14, 7
    s_or_b32 s14, s14, s31
    s_lshl_b32 s0, s14, 7
    s_add_u32 s0, s0, s7
    s_add_u32 m0, s60, 65536
    s_nop 0
    buffer_load_dwordx4 v24, s[56:59], s0 offen lds
    s_add_u32 m0, s60, 66560
    s_nop 0
    buffer_load_dwordx4 v25, s[56:59], s0 offen lds
    s_add_u32 m0, s60, 67584
    s_nop 0
    buffer_load_dwordx4 v26, s[56:59], s0 offen lds
    s_add_u32 m0, s60, 68608
    s_nop 0
    buffer_load_dwordx4 v27, s[56:59], s0 offen lds
    s_waitcnt vmcnt(12)
    s_barrier
    s_add_u32 s14, s11, 11
    s_and_b32 s14, s14, 7
    s_or_b32 s14, s14, s31
    s_mul_i32 s1, s14, 14336
    s_add_u32 s1, s1, s6
    s_add_u32 m0, s61, 65536
    s_nop 0
    buffer_load_dwordx4 v28, s[48:51], s1 offen offset:0 sc1 lds
    s_add_u32 m0, s61, 65536
    s_nop 0
    buffer_load_dwordx4 v28, s[48:51], s1 offen offset:1024 sc1 lds
    s_add_u32 m0, s61, 65536
    s_nop 0
    buffer_load_dwordx4 v28, s[48:51], s1 offen offset:2048 sc1 lds
    s_add_u32 m0, s61, 65536
    s_mov_b32 exec_hi, 0
    buffer_load_dwordx4 v28, s[48:51], s1 offen offset:3072 sc1 lds
    s_mov_b32 exec_hi, -1
    s_add_u32 s14, s11, 12
    s_and_b32 s14, s14, 7
    s_or_b32 s14, s14, s31
    s_lshl_b32 s0, s14, 7
    s_add_u32 s0, s0, s7
    s_add_u32 m0, s60, 98304
    s_nop 0
    buffer_load_dwordx4 v24, s[56:59], s0 offen lds
    s_add_u32 m0, s60, 99328
    s_nop 0
    buffer_load_dwordx4 v25, s[56:59], s0 offen lds
    s_add_u32 m0, s60, 100352
    s_nop 0
    buffer_load_dwordx4 v26, s[56:59], s0 offen lds
    s_add_u32 m0, s60, 101376
    s_nop 0
    buffer_load_dwordx4 v27, s[56:59], s0 offen lds
    s_waitcnt vmcnt(12)
    s_barrier
    s_add_u32 s14, s11, 12
    s_and_b32 s14, s14, 7
    s_or_b32 s14, s14, s31
    s_mul_i32 s1, s14, 14336
    s_add_u32 s1, s1, s6
    s_add_u32 m0, s61, 98304
    s_nop 0
    buffer_load_dwordx4 v28, s[48:51], s1 offen offset:0 sc1 lds
    s_add_u32 m0, s61, 98304
    s_nop 0
    buffer_load_dwordx4 v28, s[48:51], s1 offen offset:1024 sc1 lds
    s_add_u32 m0, s61, 98304
    s_nop 0
    buffer_load_dwordx4 v28, s[48:51], s1 offen offset:2048 sc1 lds
    s_add_u32 m0, s61, 98304
    s_mov_b32 exec_hi, 0
    buffer_load_dwordx4 v28, s[48:51], s1 offen offset:3072 sc1 lds
    s_mov_b32 exec_hi, -1
    s_add_u32 s14, s11, 13
    s_and_b32 s14, s14, 7
    s_or_b32 s14, s14, s31
    s_lshl_b32 s0, s14, 7
    s_add_u32 s0, s0, s7
    s_add_u32 m0, s60, 131072
    s_nop 0
    buffer_load_dwordx4 v24, s[56:59], s0 offen lds
    s_add_u32 m0, s60, 132096
    s_nop 0
    buffer_load_dwordx4 v25, s[56:59], s0 offen lds
    s_add_u32 m0, s60, 133120
    s_nop 0
    buffer_load_dwordx4 v26, s[56:59], s0 offen lds
    s_add_u32 m0, s60, 134144
    s_nop 0
    buffer_load_dwordx4 v27, s[56:59], s0 offen lds
    s_waitcnt vmcnt(12)
    s_barrier
    s_add_u32 s14, s11, 13
    s_and_b32 s14, s14, 7
    s_or_b32 s14, s14, s31
    s_mul_i32 s1, s14, 14336
    s_add_u32 s1, s1, s6
    s_add_u32 m0, s61, 131072
    s_nop 0
    buffer_load_dwordx4 v28, s[48:51], s1 offen offset:0 sc1 lds
    s_add_u32 m0, s61, 131072
    s_nop 0
    buffer_load_dwordx4 v28, s[48:51], s1 offen offset:1024 sc1 lds
    s_add_u32 m0, s61, 131072
    s_nop 0
    buffer_load_dwordx4 v28, s[48:51], s1 offen offset:2048 sc1 lds
    s_add_u32 m0, s61, 131072
    s_mov_b32 exec_hi, 0
    buffer_load_dwordx4 v28, s[48:51], s1 offen offset:3072 sc1 lds
    s_mov_b32 exec_hi, -1
    s_add_u32 s14, s11, 14
    s_and_b32 s14, s14, 7
    s_or_b32 s14, s14, s31
    s_lshl_b32 s0, s14, 7
    s_add_u32 s0, s0, s7
    s_add_u32 m0, s60, 0
    s_nop 0
    buffer_load_dwordx4 v24, s[56:59], s0 offen lds
    s_add_u32 m0, s60, 1024
    s_nop 0
    buffer_load_dwordx4 v25, s[56:59], s0 offen lds
    s_add_u32 m0, s60, 2048
    s_nop 0
    buffer_load_dwordx4 v26, s[56:59], s0 offen lds
    s_add_u32 m0, s60, 3072
    s_nop 0
    buffer_load_dwordx4 v27, s[56:59], s0 offen lds
    s_waitcnt vmcnt(12)
    s_barrier
    s_add_u32 s14, s11, 14
    s_and_b32 s14, s14, 7
    s_or_b32 s14, s14, s31
    s_mul_i32 s1, s14, 14336
    s_add_u32 s1, s1, s6
    s_add_u32 m0, s61, 0
    s_nop 0
    buffer_load_dwordx4 v28, s[48:51], s1 offen offset:0 sc1 lds
    s_add_u32 m0, s61, 0
    s_nop 0
    buffer_load_dwordx4 v28, s[48:51], s1 offen offset:1024 sc1 lds
    s_add_u32 m0, s61, 0
    s_nop 0
    buffer_load_dwordx4 v28, s[48:51], s1 offen offset:2048 sc1 lds
    s_add_u32 m0, s61, 0
    s_mov_b32 exec_hi, 0
    buffer_load_dwordx4 v28, s[48:51], s1 offen offset:3072 sc1 lds
    s_mov_b32 exec_hi, -1
    s_add_u32 s14, s11, 15
    s_and_b32 s14, s14, 7
    s_or_b32 s14, s14, s31
    s_lshl_b32 s0, s14, 7
    s_add_u32 s0, s0, s7
    s_add_u32 m0, s60, 32768
    s_nop 0
    buffer_load_dwordx4 v24, s[56:59], s0 offen lds
    s_add_u32 m0, s60, 33792
    s_nop 0
    buffer_load_dwordx4 v25, s[56:59], s0 offen lds
    s_add_u32 m0, s60, 34816
    s_nop 0
    buffer_load_dwordx4 v26, s[56:59], s0 offen lds
    s_add_u32 m0, s60, 35840
    s_nop 0
    buffer_load_dwordx4 v27, s[56:59], s0 offen lds
    s_waitcnt vmcnt(12)
    s_barrier
    s_add_u32 s14, s11, 15
    s_and_b32 s14, s14, 7
    s_or_b32 s14, s14, s31
    s_mul_i32 s1, s14, 14336
    s_add_u32 s1, s1, s6
    s_add_u32 m0, s61, 32768
    s_nop 0
    buffer_load_dwordx4 v28, s[48:51], s1 offen offset:0 sc1 lds
    s_add_u32 m0, s61, 32768
    s_nop 0
    buffer_load_dwordx4 v28, s[48:51], s1 offen offset:1024 sc1 lds
    s_add_u32 m0, s61, 32768
    s_nop 0
    buffer_load_dwordx4 v28, s[48:51], s1 offen offset:2048 sc1 lds
    s_add_u32 m0, s61, 32768
    s_mov_b32 exec_hi, 0
    buffer_load_dwordx4 v28, s[48:51], s1 offen offset:3072 sc1 lds
    s_mov_b32 exec_hi, -1
    s_add_u32 s14, s9, 0
    s_add_u32 m0, s60, 65536
    s_nop 0
    buffer_load_dwordx4 v33, s[44:47], s14 offen lds
    s_add_u32 s14, s9, 7168
    s_add_u32 m0, s60, 66560
    s_nop 0
    buffer_load_dwordx4 v34, s[44:47], s14 offen lds
    s_add_u32 s14, s9, 14336
    s_add_u32 m0, s60, 67584
    s_nop 0
    buffer_load_dwordx4 v33, s[44:47], s14 offen lds
    s_add_u32 s14, s9, 21504
    s_add_u32 m0, s60, 68608
    s_nop 0
    buffer_load_dwordx4 v35, s[44:47], s14 offen lds
    s_waitcnt vmcnt(12)
    s_barrier
    buffer_load_dword v31, v30, s[48:51], s13 offen sc1
    s_add_u32 s14, s9, 100352
    s_add_u32 m0, s60, 81920
    s_nop 0
    buffer_load_dwordx4 v33, s[44:47], s14 offen lds
    s_add_u32 s14, s9, 107520
    s_add_u32 m0, s60, 82944
    s_nop 0
    buffer_load_dwordx4 v34, s[44:47], s14 offen lds
    s_add_u32 s14, s9, 114688
    s_add_u32 m0, s60, 83968
    s_nop 0
    buffer_load_dwordx4 v33, s[44:47], s14 offen lds
    s_add_u32 s14, s9, 121856
    s_add_u32 m0, s60, 84992
    s_nop 0
    buffer_load_dwordx4 v35, s[44:47], s14 offen lds
    s_add_u32 s14, s9, 200704
    s_add_u32 m0, s60, 98304
    s_nop 0
    buffer_load_dwordx4 v33, s[44:47], s14 offen lds
    s_add_u32 s14, s9, 207872
    s_add_u32 m0, s60, 99328
    s_nop 0
    buffer_load_dwordx4 v34, s[44:47], s14 offen lds
    s_add_u32 s14, s9, 215040
    s_add_u32 m0, s60, 100352
    s_nop 0
    buffer_load_dwordx4 v33, s[44:47], s14 offen lds
    s_add_u32 s14, s9, 222208
    s_add_u32 m0, s60, 101376
    s_nop 0
    buffer_load_dwordx4 v35, s[44:47], s14 offen lds
    s_waitcnt vmcnt(13)
    s_barrier
    s_waitcnt vmcnt(8)
    v_cmp_ne_u32 vcc, s38, v31
    s_cbranch_vccz po_11
    s_mov_b32 s39, 0
pob_12:
    buffer_load_dword v31, v30, s[48:51], s13 offen sc1
    s_add_u32 s39, s39, 1
    s_waitcnt vmcnt(0)
    v_cmp_ne_u32 vcc, s38, v31
    s_cmp_ge_u32 s39, 20000
    s_cbranch_scc1 pob_12_x
    s_cbranch_vccz pob_12_x
    s_sleep 4
    s_branch pob_12
pob_12_x:
po_11:
    s_add_u32 s14, s9, 301056
    s_add_u32 m0, s60, 114688
    s_nop 0
    buffer_load_dwordx4 v33, s[44:47], s14 offen lds
    s_add_u32 s14, s9, 308224
    s_add_u32 m0, s60, 115712
    s_nop 0
    buffer_load_dwordx4 v34, s[44:47], s14 offen lds
    s_add_u32 s14, s9, 315392
    s_add_u32 m0, s60, 116736
    s_nop 0
    buffer_load_dwordx4 v33, s[44:47], s14 offen lds
    s_add_u32 s14, s9, 322560
    s_add_u32 m0, s60, 117760
    s_nop 0
    buffer_load_dwordx4 v35, s[44:47], s14 offen lds
    s_barrier
g1_join:
    s_lshl_b32 s10, s101, 12
    s_add_u32 s10, s10, s62
    s_add_u32 s10, s10, 12582912
    s_mov_b32 s8, s63
    s_add_u32 s9, s62, 131072
    s_mov_b32 s12, 0
g1_ol:
    s_and_b32 s14, s8, 7
    s_lshl_b32 s15, s14, 12
    s_add_u32 m0, s15, s9
    s_lshl_b32 s14, s14, 17
    s_add_u32 s14, s14, s10
    buffer_load_dwordx4 v28, s[48:51], s14 offen sc1 lds
    s_add_u32 s8, s8, 1
    s_add_u32 s12, s12, 1
    s_cmp_eq_u32 s12, 8
    s_cselect_b32 s14, 4294836224, 0
    s_cselect_b32 s15, 1048576, 0
    s_add_u32 s9, s9, s14
    s_add_u32 s10, s10, s15
    s_cmp_lt_u32 s12, 16
    s_cbranch_scc1 g1_ol
    s_lshl_b32 s9, s96, 2
    s_add_u32 s9, s9, s97
    s_lshl_b32 s9, s9, 4
    s_add_u32 s9, s9, s98
    s_lshl_b32 s8, s9, 13
    s_add_u32 s8, s8, 14680064
    s_lshl_b32 s14, s3, 11
    s_add_u32 s8, s8, s14
    s_xor_b32 s9, s98, 1
    s_xor_b32 s10, s98, 2
    s_xor_b32 s11, s98, 3
    s_lshl_b32 s9, s9, 15
    s_lshl_b32 s10, s10, 15
    s_lshl_b32 s11, s11, 15
    s_add_u32 s9, s9, s8
    s_add_u32 s10, s10, s8
    s_add_u32 s11, s11, s8
    s_add_u32 s14, s14, 32768
    v_add_u32 v4, s14, v28
    s_lshl_b32 s14, s98, 15
    s_add_u32 s8, s8, s14
    s_cmp_lt_u32 s98, 2
    s_cselect_b32 s61, 0, 0x80008000
    s_lshl_b32 s12, s96, 7
    s_lshl_b32 s14, s98, 5
    s_add_u32 s12, s12, s14
    s_lshr_b32 s14, s3, 1
    s_lshl_b32 s14, s14, 4
    s_add_u32 s12, s12, s14
    s_mul_i32 s12, s12, 1792
    s_mul_i32 s14, s97, 224
    s_add_u32 s12, s12, s14
    s_and_b32 s14, s3, 1
    s_mul_i32 s14, s14, 28
    s_add_u32 s12, s12, s14
    s_add_u32 s12, s12, 896
    v_and_b32 v17, 15, v1
    v_mul_u32_u24 v17, 1792, v17
    v_lshrrev_b32 v18, 4, v1
    v_mul_u32_u24 v18, 56, v18
    v_add_u32 v5, v17, v18
    s_mov_b32 s60, 0xffff0000
    buffer_load_dwordx4 v[48:51], v28, s[48:51], s9 offen offset:0 sc1
    buffer_load_dwordx4 v[52:55], v28, s[48:51], s9 offen offset:1024 sc1
    buffer_load_dwordx4 v[56:59], v28, s[48:51], s10 offen offset:0 sc1
    buffer_load_dwordx4 v[60:63], v28, s[48:51], s10 offen offset:1024 sc1
    buffer_load_dwordx4 v[64:67], v28, s[48:51], s11 offen offset:0 sc1
    buffer_load_dwordx4 v[68:71], v28, s[48:51], s11 offen offset:1024 sc1
    s_waitcnt vmcnt(6)
    s_barrier
    ds_read_b128 v[40:43], v4
    ds_read_b128 v[44:47], v4 offset:1024
    s_mov_b32 s39, 0
    s_branch g1_pp1
g1_pp:
    buffer_load_dwordx4 v[48:51], v28, s[48:51], s9 offen offset:0 sc1
    buffer_load_dwordx4 v[52:55], v28, s[48:51], s9 offen offset:1024 sc1
    buffer_load_dwordx4 v[56:59], v28, s[48:51], s10 offen offset:0 sc1
    buffer_load_dwordx4 v[60:63], v28, s[48:51], s10 offen offset:1024 sc1
    buffer_load_dwordx4 v[64:67], v28, s[48:51], s11 offen offset:0 sc1
    buffer_load_dwordx4 v[68:71], v28, s[48:51], s11 offen offset:1024 sc1
g1_pp1:
    s_add_u32 s39, s39, 1
    s_waitcnt vmcnt(0) lgkmcnt(0)
    v_xor_b32 v17, s35, v43
    v_xor_b32 v18, s35, v47
    v_or_b32 v17, v17, v18
    v_xor_b32 v18, s35, v51
    v_or_b32 v17, v17, v18
    v_xor_b32 v18, s35, v55
    v_or_b32 v17, v17, v18
    v_xor_b32 v18, s35, v59
    v_or_b32 v17, v17, v18
    v_xor_b32 v18, s35, v63
    v_or_b32 v17, v17, v18
    v_xor_b32 v18, s35, v67
    v_or_b32 v17, v17, v18
    v_xor_b32 v18, s35, v71
    v_or_b32 v17, v17, v18
    v_cmp_le_u32 vcc, 0x10000, v17
    s_cmp_ge_u32 s39, 20000
    s_cbranch_scc1 g1_ppx
    s_cbranch_vccz g1_ppx
    s_sleep 4
    s_branch g1_pp
g1_ppx:
    v_lshlrev_b32 v80, 16, v40
    v_lshlrev_b32 v81, 16, v48
    v_lshlrev_b32 v82, 16, v56
    v_lshlrev_b32 v83, 16, v64
    v_add_f32 v80, v80, v81
    v_add_f32 v82, v82, v83
    v_sub_f32 v104, v80, v82
    v_and_b32 v80, s60, v40
    v_and_b32 v81, s60, v48
    v_and_b32 v82, s60, v56
    v_and_b32 v83, s60, v64
    v_add_f32 v80, v80, v81
    v_add_f32 v82, v82, v83
    v_sub_f32 v105, v80, v82
    v_lshlrev_b32 v80, 16, v41
    v_lshlrev_b32 v81, 16, v49
    v_lshlrev_b32 v82, 16, v57
    v_lshlrev_b32 v83, 16, v65
    v_add_f32 v80, v80, v81
    v_add_f32 v82, v82, v83
    v_sub_f32 v106, v80, v82
    v_and_b32 v80, s60, v41
    v_and_b32 v81, s60, v49
    v_and_b32 v82, s60, v57
    v_and_b32 v83, s60, v65
    v_add_f32 v80, v80, v81
    v_add_f32 v82, v82, v83
    v_sub_f32 v107, v80, v82
    v_lshlrev_b32 v80, 16, v42
    v_lshlrev_b32 v81, 16, v50
    v_lshlrev_b32 v82, 16, v58
    v_lshlrev_b32 v83, 16, v66
    v_add_f32 v80, v80, v81
    v_add_f32 v82, v82, v83
    v_sub_f32 v108, v80, v82
    v_and_b32 v80, s60, v42
    v_and_b32 v81, s60, v50
    v_and_b32 v82, s60, v58
    v_and_b32 v83, s60, v66
    v_add_f32 v80, v80, v81
    v_add_f32 v82, v82, v83
    v_sub_f32 v109, v80, v82
    v_lshlrev_b32 v80, 16, v43
    v_lshlrev_b32 v81, 16, v51
    v_lshlrev_b32 v82, 16, v59
    v_lshlrev_b32 v83, 16, v67
    v_add_f32 v80, v80, v81
    v_add_f32 v82, v82, v83
    v_sub_f32 v110, v80, v82
    v_lshlrev_b32 v80, 16, v44
    v_lshlrev_b32 v81, 16, v52
    v_lshlrev_b32 v82, 16, v60
    v_lshlrev_b32 v83, 16, v68
    v_add_f32 v80, v80, v81
    v_add_f32 v82, v82, v83
    v_sub_f32 v111, v80, v82
    v_and_b32 v80, s60, v44
    v_and_b32 v81, s60, v52
    v_and_b32 v82, s60, v60
    v_and_b32 v83, s60, v68
    v_add_f32 v80, v80, v81
    v_add_f32 v82, v82, v83
    v_sub_f32 v112, v80, v82
    v_lshlrev_b32 v80, 16, v45
    v_lshlrev_b32 v81, 16, v53
    v_lshlrev_b32 v82, 16, v61
    v_lshlrev_b32 v83, 16, v69
    v_add_f32 v80, v80, v81
    v_add_f32 v82, v82, v83
    v_sub_f32 v113, v80, v82
    v_and_b32 v80, s60, v45
    v_and_b32 v81, s60, v53
    v_and_b32 v82, s60, v61
    v_and_b32 v83, s60, v69
    v_add_f32 v80, v80, v81
    v_add_f32 v82, v82, v83
    v_sub_f32 v114, v80, v82
    v_lshlrev_b32 v80, 16, v46
    v_lshlrev_b32 v81, 16, v54
    v_lshlrev_b32 v82, 16, v62
    v_lshlrev_b32 v83, 16, v70
    v_add_f32 v80, v80, v81
    v_add_f32 v82, v82, v83
    v_sub_f32 v115, v80, v82
    v_and_b32 v80, s60, v46
    v_and_b32 v81, s60, v54
    v_and_b32 v82, s60, v62
    v_and_b32 v83, s60, v70
    v_add_f32 v80, v80, v81
    v_add_f32 v82, v82, v83
    v_sub_f32 v116, v80, v82
    v_lshlrev_b32 v80, 16, v47
    v_lshlrev_b32 v81, 16, v55
    v_lshlrev_b32 v82, 16, v63
    v_lshlrev_b32 v83, 16, v71
    v_add_f32 v80, v80, v81
    v_add_f32 v82, v82, v83
    v_sub_f32 v117, v80, v82
    v_cvt_pk_bf16_f32 v88, v104, v105
    v_xor_b32 v88, s61, v88
    v_cvt_pk_bf16_f32 v89, v106, v107
    v_xor_b32 v89, s61, v89
    v_cvt_pk_bf16_f32 v90, v108, v109
    v_xor_b32 v90, s61, v90
    v_cvt_pk_bf16_f32 v91, v110, v111
    v_xor_b32 v91, s61, v91
    v_cvt_pk_bf16_f32 v92, v112, v113
    v_xor_b32 v92, s61, v92
    v_cvt_pk_bf16_f32 v93, v114, v115
    v_xor_b32 v93, s61, v93
    v_cvt_pk_bf16_f32 v94, v116, v117
    v_xor_b32 v94, s61, v94
    buffer_store_dwordx4 v[88:91], v5, s[52:55], s12 offen
    buffer_store_dwordx3 v[92:94], v5, s[52:55], s12 offen offset:16
g1_done:
    s_endpgm
g0_entry:
    s_lshr_b32 s98, s4, 1
    s_and_b32 s96, s4, 1
    s_lshl_b32 s96, s96, 3
    s_and_b32 s14, s5, 7
    s_add_u32 s96, s96, s14
    s_lshr_b32 s97, s5, 3
    s_lshl_b32 s99, s4, 1
    s_lshr_b32 s14, s5, 4
    s_add_u32 s99, s99, s14
    s_and_b32 s100, s5, 15
    s_mul_i32 s14, s5, 37
    s_lshr_b32 s14, s14, 8
    s_mul_i32 s15, s14, 7
    s_sub_u32 s63, s5, s15
    s_min_u32 s14, s14, 3
    s_lshl_b32 s101, s4, 2
    s_add_u32 s101, s101, s14
    s_waitcnt lgkmcnt(0)
    s_mov_b32 s48, s36
    s_and_b32 s49, s37, 0xffff
    s_mov_b32 s50, 25165824
    s_mov_b32 s51, 0x20000
    s_mov_b32 s52, s32
    s_and_b32 s53, s33, 0xffff
    s_mov_b32 s54, 3670016
    s_mov_b32 s55, 0x20000
    s_add_u32 s14, s36, 393216
    s_addc_u32 s15, s37, 0
    s_load_dword s39, s[14:15], 0
    s_waitcnt lgkmcnt(0)
    s_mul_i32 s38, s39, 0x19660d
    s_add_u32 s38, s38, 0x3c6ef35f
    s_and_b32 s14, s38, 0xfff
    s_or_b32 s14, s14, 0x4000
    s_lshr_b32 s15, s39, 16
    s_cmp_eq_u32 s14, s15
    s_cselect_b32 s15, 0x1000, 0
    s_or_b32 s14, s14, s15
    s_lshl_b32 s35, s14, 16
    s_cmp_lt_u32 s98, 2
    s_cselect_b32 s40, s24, s26
    s_cselect_b32 s41, s25, s27
    s_and_b32 s41, s41, 0xffff
    s_mov_b32 s42, 8388608
    s_mov_b32 s43, 0x20000
    s_mov_b32 s44, s20
    s_and_b32 s45, s21, 0xffff
    s_mov_b32 s46, 401408
    s_mov_b32 s47, 0x20000
    v_lshlrev_b32 v2, 20, v1
    s_cmp_lg_u32 s3, 0
    s_cbranch_scc1 tlb_done
    buffer_load_dword v3, v2, s[48:51], 0 offen sc1
    buffer_load_dword v3, v2, s[40:43], 0 offen
    buffer_load_dword v3, v2, s[52:55], 0 offen sc1
    buffer_load_dword v3, v2, s[44:47], 0 offen
tlb_done:
    s_cmp_ge_u32 s5, 16
    s_cbranch_scc1 g0_p1b
    s_mov_b32 s24, 7
    s_mov_b32 s25, 5
    s_mov_b32 s26, 65536
    s_mov_b32 s27, 4
    s_mov_b32 s28, 65536
    s_mov_b32 s29, 98304
    s_lshr_b32 s14, s3, 1
    s_lshl_b32 s14, s14, 13
    v_and_b32 v17, 15, v1
    v_lshrrev_b32 v18, 1, v17
    v_lshrrev_b32 v14, 4, v1
    v_xor_b32 v14, v14, v18
    v_lshlrev_b32 v14, 4, v14
    v_lshl_add_u32 v14, v17, 7, v14
    v_add_u32 v14, s14, v14
    v_xor_b32 v15, 64, v14
    s_and_b32 s14, s3, 1
    s_mul_i32 s14, s14, 168
    s_add_u32 s14, s14, 16384
    v_lshrrev_b32 v17, 2, v1
    v_mul_u32_u24 v17, 672, v17
    v_and_b32 v18, 3, v1
    v_lshl_add_u32 v17, v18, 3, v17
    v_add_u32 v16, s14, v17
    v_mov_b32 v104, 0
    v_mov_b32 v105, 0
    v_mov_b32 v106, 0
    v_mov_b32 v107, 0
    v_mov_b32 v108, 0
    v_mov_b32 v109, 0
    v_mov_b32 v110, 0
    v_mov_b32 v111, 0
    v_mov_b32 v112, 0
    v_mov_b32 v113, 0
    v_mov_b32 v114, 0
    v_mov_b32 v115, 0
    v_mov_b32 v116, 0
    v_mov_b32 v117, 0
    v_mov_b32 v118, 0
    v_mov_b32 v119, 0
    v_mov_b32 v120, 0
    v_mov_b32 v121, 0
    v_mov_b32 v122, 0
    v_mov_b32 v123, 0
    v_mov_b32 v124, 0
    v_mov_b32 v125, 0
    v_mov_b32 v126, 0
    v_mov_b32 v127, 0
    v_mov_b32 v128, 0
    v_mov_b32 v129, 0
    v_mov_b32 v130, 0
    v_mov_b32 v131, 0
    v_mov_b32 v132, 0
    v_mov_b32 v133, 0
    v_mov_b32 v134, 0
    v_mov_b32 v135, 0
    v_mov_b32 v136, 0
    v_mov_b32 v137, 0
    v_mov_b32 v138, 0
    v_mov_b32 v139, 0
    v_mov_b32 v140, 0
    v_mov_b32 v141, 0
    v_mov_b32 v142, 0
    v_mov_b32 v143, 0
    v_mov_b32 v144, 0
    v_mov_b32 v145, 0
    v_mov_b32 v146, 0
    v_mov_b32 v147, 0
    v_mov_b32 v148, 0
    v_mov_b32 v149, 0
    v_mov_b32 v150, 0
    v_mov_b32 v151, 0
    v_mov_b32 v152, 0
    v_mov_b32 v153, 0
    v_mov_b32 v154, 0
    v_mov_b32 v155, 0
    v_mov_b32 v156, 0
    v_mov_b32 v157, 0
    v_mov_b32 v158, 0
    v_mov_b32 v159, 0
    v_mov_b32 v160, 0
    v_mov_b32 v161, 0
    v_mov_b32 v162, 0
    v_mov_b32 v163, 0
    v_mov_b32 v164, 0
    v_mov_b32 v165, 0
    v_mov_b32 v166, 0
    v_mov_b32 v167, 0
    v_mov_b32 v168, 0
    v_mov_b32 v169, 0
    v_mov_b32 v170, 0
    v_mov_b32 v171, 0
    v_mov_b32 v172, 0
    v_mov_b32 v173, 0
    v_mov_b32 v174, 0
    v_mov_b32 v175, 0
    v_mov_b32 v176, 0
    v_mov_b32 v177, 0
    v_mov_b32 v178, 0
    v_mov_b32 v179, 0
    v_mov_b32 v180, 0
    v_mov_b32 v181, 0
    v_mov_b32 v182, 0
    v_mov_b32 v183, 0
    v_mov_b32 v184, 0
    v_mov_b32 v185, 0
    v_mov_b32 v186, 0
    v_mov_b32 v187, 0
    v_mov_b32 v188, 0
    v_mov_b32 v189, 0
    v_mov_b32 v190, 0
    v_mov_b32 v191, 0
    v_mov_b32 v192, 0
    v_mov_b32 v193, 0
    v_mov_b32 v194, 0
    v_mov_b32 v195, 0
    v_mov_b32 v196, 0
    v_mov_b32 v197, 0
    v_mov_b32 v198, 0
    v_mov_b32 v199, 0
    s_mov_b32 s9, 0
    s_barrier
    ds_read_b64_tr_b16 v[40:41], v16 offset:0
    ds_read_b64_tr_b16 v[42:43], v16 offset:336
    ds_read_b128 v[24:27], v14 offset:0
    ds_read_b128 v[28:31], v14 offset:2048
    ds_read_b128 v[32:35], v14 offset:4096
    ds_read_b128 v[36:39], v14 offset:6144
    ds_read_b64_tr_b16 v[44:45], v16 offset:32
    ds_read_b64_tr_b16 v[46:47], v16 offset:368
    ds_read_b64_tr_b16 v[48:49], v16 offset:56
    ds_read_b64_tr_b16 v[50:51], v16 offset:392
    ds_read_b64_tr_b16 v[52:53], v16 offset:88
    ds_read_b64_tr_b16 v[54:55], v16 offset:424
    ds_read_b64_tr_b16 v[56:57], v16 offset:112
    ds_read_b64_tr_b16 v[58:59], v16 offset:448
    ds_read_b64_tr_b16 v[60:61], v16 offset:144
    ds_read_b64_tr_b16 v[62:63], v16 offset:480
    s_mov_b32 s10, 7
a1_13:
    s_waitcnt lgkmcnt(13)
    v_mfma_f32_16x16x32_bf16 v[104:107], v[40:43], v[24:27], v[104:107]
    ds_read_b64_tr_b16 v[80:81], v16 offset:10752
    s_waitcnt lgkmcnt(13)
    v_mfma_f32_16x16x32_bf16 v[108:111], v[40:43], v[28:31], v[108:111]
    ds_read_b64_tr_b16 v[82:83], v16 offset:11088
    s_waitcnt lgkmcnt(13)
    v_mfma_f32_16x16x32_bf16 v[112:115], v[40:43], v[32:35], v[112:115]
    s_add_u32 s9, s9, 1
    s_cmp_eq_u32 s9, 4
    s_waitcnt lgkmcnt(12)
    v_mfma_f32_16x16x32_bf16 v[116:119], v[40:43], v[36:39], v[116:119]
    ds_read_b128 v[64:67], v15 offset:0
    s_waitcnt lgkmcnt(11)
    v_mfma_f32_16x16x32_bf16 v[120:123], v[44:47], v[24:27], v[120:123]
    ds_read_b128 v[68:71], v15 offset:2048
    v_mfma_f32_16x16x32_bf16 v[124:127], v[44:47], v[28:31], v[124:127]
    s_cselect_b32 s11, -3, 1
    s_cselect_b32 s9, 0, s9
    v_mfma_f32_16x16x32_bf16 v[128:131], v[44:47], v[32:35], v[128:131]
    ds_read_b128 v[72:75], v15 offset:4096
    v_mfma_f32_16x16x32_bf16 v[132:135], v[44:47], v[36:39], v[132:135]
    ds_read_b128 v[76:79], v15 offset:6144
    s_waitcnt lgkmcnt(12)
    v_mfma_f32_16x16x32_bf16 v[136:139], v[48:51], v[24:27], v[136:139]
    s_mul_i32 s11, s11, 37888
    v_mfma_f32_16x16x32_bf16 v[140:143], v[48:51], v[28:31], v[140:143]
    ds_read_b64_tr_b16 v[84:85], v16 offset:10784
    v_mfma_f32_16x16x32_bf16 v[144:147], v[48:51], v[32:35], v[144:147]
    ds_read_b64_tr_b16 v[86:87], v16 offset:11120
    v_mfma_f32_16x16x32_bf16 v[148:151], v[48:51], v[36:39], v[148:151]
    v_add_u32 v14, s11, v14
    s_waitcnt lgkmcnt(12)
    v_mfma_f32_16x16x32_bf16 v[152:155], v[52:55], v[24:27], v[152:155]
    ds_read_b64_tr_b16 v[88:89], v16 offset:10808
    v_mfma_f32_16x16x32_bf16 v[156:159], v[52:55], v[28:31], v[156:159]
    ds_read_b64_tr_b16 v[90:91], v16 offset:11144
    v_mfma_f32_16x16x32_bf16 v[160:163], v[52:55], v[32:35], v[160:163]
    v_mfma_f32_16x16x32_bf16 v[164:167], v[52:55], v[36:39], v[164:167]
    ds_read_b64_tr_b16 v[92:93], v16 offset:10840
    s_waitcnt lgkmcnt(13)
    v_mfma_f32_16x16x32_bf16 v[168:171], v[56:59], v[24:27], v[168:171]
    ds_read_b64_tr_b16 v[94:95], v16 offset:11176
    v_mfma_f32_16x16x32_bf16 v[172:175], v[56:59], v[28:31], v[172:175]
    v_mfma_f32_16x16x32_bf16 v[176:179], v[56:59], v[32:35], v[176:179]
    ds_read_b64_tr_b16 v[96:97], v16 offset:10864
    v_mfma_f32_16x16x32_bf16 v[180:183], v[56:59], v[36:39], v[180:183]
    ds_read_b64_tr_b16 v[98:99], v16 offset:11200
    s_waitcnt lgkmcnt(14)
    v_mfma_f32_16x16x32_bf16 v[184:187], v[60:63], v[24:27], v[184:187]
    v_mfma_f32_16x16x32_bf16 v[188:191], v[60:63], v[28:31], v[188:191]
    ds_read_b64_tr_b16 v[100:101], v16 offset:10896
    v_mfma_f32_16x16x32_bf16 v[192:195], v[60:63], v[32:35], v[192:195]
    ds_read_b64_tr_b16 v[102:103], v16 offset:11232
    v_mfma_f32_16x16x32_bf16 v[196:199], v[60:63], v[36:39], v[196:199]
    v_add_u32 v16, s11, v16
    s_barrier
    s_waitcnt lgkmcnt(13)
    v_mfma_f32_16x16x32_bf16 v[104:107], v[80:83], v[64:67], v[104:107]
    ds_read_b64_tr_b16 v[40:41], v16 offset:0
    s_waitcnt lgkmcnt(13)
    v_mfma_f32_16x16x32_bf16 v[108:111], v[80:83], v[68:71], v[108:111]
    ds_read_b64_tr_b16 v[42:43], v16 offset:336
    s_waitcnt lgkmcnt(13)
    v_mfma_f32_16x16x32_bf16 v[112:115], v[80:83], v[72:75], v[112:115]
    v_add_u32 v15, s11, v15
    s_waitcnt lgkmcnt(12)
    v_mfma_f32_16x16x32_bf16 v[116:119], v[80:83], v[76:79], v[116:119]
    ds_read_b128 v[24:27], v14 offset:0
    s_waitcnt lgkmcnt(11)
    v_mfma_f32_16x16x32_bf16 v[120:123], v[84:87], v[64:67], v[120:123]
    ds_read_b128 v[28:31], v14 offset:2048
    v_mfma_f32_16x16x32_bf16 v[124:127], v[84:87], v[68:71], v[124:127]
    s_sub_u32 s10, s10, 1
    s_cmp_lg_u32 s10, 0
    v_mfma_f32_16x16x32_bf16 v[128:131], v[84:87], v[72:75], v[128:131]
    ds_read_b128 v[32:35], v14 offset:4096
    v_mfma_f32_16x16x32_bf16 v[132:135], v[84:87], v[76:79], v[132:135]
    ds_read_b128 v[36:39], v14 offset:6144
    s_waitcnt lgkmcnt(12)
    v_mfma_f32_16x16x32_bf16 v[136:139], v[88:91], v[64:67], v[136:139]
    v_mfma_f32_16x16x32_bf16 v[140:143], v[88:91], v[68:71], v[140:143]
    ds_read_b64_tr_b16 v[44:45], v16 offset:32
    v_mfma_f32_16x16x32_bf16 v[144:147], v[88:91], v[72:75], v[144:147]
    ds_read_b64_tr_b16 v[46:47], v16 offset:368
    v_mfma_f32_16x16x32_bf16 v[148:151], v[88:91], v[76:79], v[148:151]
    s_waitcnt lgkmcnt(12)
    v_mfma_f32_16x16x32_bf16 v[152:155], v[92:95], v[64:67], v[152:155]
    ds_read_b64_tr_b16 v[48:49], v16 offset:56
    v_mfma_f32_16x16x32_bf16 v[156:159], v[92:95], v[68:71], v[156:159]
    ds_read_b64_tr_b16 v[50:51], v16 offset:392
    v_mfma_f32_16x16x32_bf16 v[160:163], v[92:95], v[72:75], v[160:163]
    v_mfma_f32_16x16x32_bf16 v[164:167], v[92:95], v[76:79], v[164:167]
    ds_read_b64_tr_b16 v[52:53], v16 offset:88
    s_waitcnt lgkmcnt(13)
    v_mfma_f32_16x16x32_bf16 v[168:171], v[96:99], v[64:67], v[168:171]
    ds_read_b64_tr_b16 v[54:55], v16 offset:424
    v_mfma_f32_16x16x32_bf16 v[172:175], v[96:99], v[68:71], v[172:175]
    v_mfma_f32_16x16x32_bf16 v[176:179], v[96:99], v[72:75], v[176:179]
    ds_read_b64_tr_b16 v[56:57], v16 offset:112
    v_mfma_f32_16x16x32_bf16 v[180:183], v[96:99], v[76:79], v[180:183]
    ds_read_b64_tr_b16 v[58:59], v16 offset:448
    s_waitcnt lgkmcnt(14)
    v_mfma_f32_16x16x32_bf16 v[184:187], v[100:103], v[64:67], v[184:187]
    v_mfma_f32_16x16x32_bf16 v[188:191], v[100:103], v[68:71], v[188:191]
    ds_read_b64_tr_b16 v[60:61], v16 offset:144
    v_mfma_f32_16x16x32_bf16 v[192:195], v[100:103], v[72:75], v[192:195]
    ds_read_b64_tr_b16 v[62:63], v16 offset:480
    v_mfma_f32_16x16x32_bf16 v[196:199], v[100:103], v[76:79], v[196:199]
    s_cbranch_scc1 a1_13
    s_waitcnt lgkmcnt(0)
    s_mul_i32 s9, s7, 6
    s_and_b32 s14, s3, 1
    s_mul_i32 s14, s14, 3
    s_add_u32 s9, s9, s14
    s_lshl_b32 s10, s6, 3
    s_lshr_b32 s14, s3, 1
    s_lshl_b32 s14, s14, 2
    s_add_u32 s10, s10, s14
    s_lshl_b32 s10, s10, 10
    s_add_u32 s10, s10, 1048576
    v_lshlrev_b32 v17, 4, v1
    s_mov_b32 s56, 0
    s_mov_b32 s57, 0xffff0000
    s_add_u32 s11, s9, 0
    s_lshl_b32 s12, s11, 17
    s_add_u32 s12, s12, s10
    s_cmp_lt_u32 s11, 16
    s_cselect_b32 s60, 1049335798, 1.0
    s_cselect_b32 s61, 1049335798, 1.0
    s_sub_u32 s14, s11, 16
    s_cmp_lt_u32 s14, 16
    s_cselect_b32 s14, 0, 0x3f80
    v_mov_b32 v18, s14
    v_pk_mul_f32 v[104:105], v[104:105], s[60:61]
    v_pk_mul_f32 v[106:107], v[106:107], s[60:61]
    v_pk_mul_f32 v[120:121], v[120:121], s[60:61]
    v_pk_mul_f32 v[122:123], v[122:123], s[60:61]
    v_cvt_pk_bf16_f32 v24, v104, v105
    v_cvt_pk_bf16_f32 v25, v106, v107
    v_cvt_pk_bf16_f32 v26, v120, v121
    v_cvt_pk_bf16_f32 v27, v122, v123
    v_cndmask_b32 v26, v26, v18, s[56:57]
    v_cndmask_b32 v27, v27, 0, s[56:57]
    buffer_store_dwordx4 v[24:27], v17, s[48:51], s12 offen offset:0 sc1
    v_pk_mul_f32 v[108:109], v[108:109], s[60:61]
    v_pk_mul_f32 v[110:111], v[110:111], s[60:61]
    v_pk_mul_f32 v[124:125], v[124:125], s[60:61]
    v_pk_mul_f32 v[126:127], v[126:127], s[60:61]
    v_cvt_pk_bf16_f32 v28, v108, v109
    v_cvt_pk_bf16_f32 v29, v110, v111
    v_cvt_pk_bf16_f32 v30, v124, v125
    v_cvt_pk_bf16_f32 v31, v126, v127
    v_cndmask_b32 v30, v30, v18, s[56:57]
    v_cndmask_b32 v31, v31, 0, s[56:57]
    buffer_store_dwordx4 v[28:31], v17, s[48:51], s12 offen offset:1024 sc1
    v_pk_mul_f32 v[112:113], v[112:113], s[60:61]
    v_pk_mul_f32 v[114:115], v[114:115], s[60:61]
    v_pk_mul_f32 v[128:129], v[128:129], s[60:61]
    v_pk_mul_f32 v[130:131], v[130:131], s[60:61]
    v_cvt_pk_bf16_f32 v32, v112, v113
    v_cvt_pk_bf16_f32 v33, v114, v115
    v_cvt_pk_bf16_f32 v34, v128, v129
    v_cvt_pk_bf16_f32 v35, v130, v131
    v_cndmask_b32 v34, v34, v18, s[56:57]
    v_cndmask_b32 v35, v35, 0, s[56:57]
    buffer_store_dwordx4 v[32:35], v17, s[48:51], s12 offen offset:2048 sc1
    v_pk_mul_f32 v[116:117], v[116:117], s[60:61]
    v_pk_mul_f32 v[118:119], v[118:119], s[60:61]
    v_pk_mul_f32 v[132:133], v[132:133], s[60:61]
    v_pk_mul_f32 v[134:135], v[134:135], s[60:61]
    v_cvt_pk_bf16_f32 v36, v116, v117
    v_cvt_pk_bf16_f32 v37, v118, v119
    v_cvt_pk_bf16_f32 v38, v132, v133
    v_cvt_pk_bf16_f32 v39, v134, v135
    v_cndmask_b32 v38, v38, v18, s[56:57]
    v_cndmask_b32 v39, v39, 0, s[56:57]
    buffer_store_dwordx4 v[36:39], v17, s[48:51], s12 offen offset:3072 sc1
    s_add_u32 s11, s9, 1
    s_lshl_b32 s12, s11, 17
    s_add_u32 s12, s12, s10
    s_cmp_lt_u32 s11, 16
    s_cselect_b32 s60, 1049335798, 1.0
    s_cselect_b32 s61, 1049335798, 1.0
    s_sub_u32 s14, s11, 16
    s_cmp_lt_u32 s14, 16
    s_cselect_b32 s14, 0, 0x3f80
    v_mov_b32 v18, s14
    v_pk_mul_f32 v[136:137], v[136:137], s[60:61]
    v_pk_mul_f32 v[138:139], v[138:139], s[60:61]
    v_pk_mul_f32 v[152:153], v[152:153], s[60:61]
    v_pk_mul_f32 v[154:155], v[154:155], s[60:61]
    v_cvt_pk_bf16_f32 v40, v136, v137
    v_cvt_pk_bf16_f32 v41, v138, v139
    v_cvt_pk_bf16_f32 v42, v152, v153
    v_cvt_pk_bf16_f32 v43, v154, v155
    v_cndmask_b32 v42, v42, v18, s[56:57]
    v_cndmask_b32 v43, v43, 0, s[56:57]
    buffer_store_dwordx4 v[40:43], v17, s[48:51], s12 offen offset:0 sc1
    v_pk_mul_f32 v[140:141], v[140:141], s[60:61]
    v_pk_mul_f32 v[142:143], v[142:143], s[60:61]
    v_pk_mul_f32 v[156:157], v[156:157], s[60:61]
    v_pk_mul_f32 v[158:159], v[158:159], s[60:61]
    v_cvt_pk_bf16_f32 v44, v140, v141
    v_cvt_pk_bf16_f32 v45, v142, v143
    v_cvt_pk_bf16_f32 v46, v156, v157
    v_cvt_pk_bf16_f32 v47, v158, v159
    v_cndmask_b32 v46, v46, v18, s[56:57]
    v_cndmask_b32 v47, v47, 0, s[56:57]
    buffer_store_dwordx4 v[44:47], v17, s[48:51], s12 offen offset:1024 sc1
    v_pk_mul_f32 v[144:145], v[144:145], s[60:61]
    v_pk_mul_f32 v[146:147], v[146:147], s[60:61]
    v_pk_mul_f32 v[160:161], v[160:161], s[60:61]
    v_pk_mul_f32 v[162:163], v[162:163], s[60:61]
    v_cvt_pk_bf16_f32 v48, v144, v145
    v_cvt_pk_bf16_f32 v49, v146, v147
    v_cvt_pk_bf16_f32 v50, v160, v161
    v_cvt_pk_bf16_f32 v51, v162, v163
    v_cndmask_b32 v50, v50, v18, s[56:57]
    v_cndmask_b32 v51, v51, 0, s[56:57]
    buffer_store_dwordx4 v[48:51], v17, s[48:51], s12 offen offset:2048 sc1
    v_pk_mul_f32 v[148:149], v[148:149], s[60:61]
    v_pk_mul_f32 v[150:151], v[150:151], s[60:61]
    v_pk_mul_f32 v[164:165], v[164:165], s[60:61]
    v_pk_mul_f32 v[166:167], v[166:167], s[60:61]
    v_cvt_pk_bf16_f32 v52, v148, v149
    v_cvt_pk_bf16_f32 v53, v150, v151
    v_cvt_pk_bf16_f32 v54, v164, v165
    v_cvt_pk_bf16_f32 v55, v166, v167
    v_cndmask_b32 v54, v54, v18, s[56:57]
    v_cndmask_b32 v55, v55, 0, s[56:57]
    buffer_store_dwordx4 v[52:55], v17, s[48:51], s12 offen offset:3072 sc1
    s_add_u32 s11, s9, 2
    s_lshl_b32 s12, s11, 17
    s_add_u32 s12, s12, s10
    s_cmp_lt_u32 s11, 16
    s_cselect_b32 s60, 1049335798, 1.0
    s_cselect_b32 s61, 1049335798, 1.0
    s_sub_u32 s14, s11, 16
    s_cmp_lt_u32 s14, 16
    s_cselect_b32 s14, 0, 0x3f80
    v_mov_b32 v18, s14
    v_pk_mul_f32 v[168:169], v[168:169], s[60:61]
    v_pk_mul_f32 v[170:171], v[170:171], s[60:61]
    v_pk_mul_f32 v[184:185], v[184:185], s[60:61]
    v_pk_mul_f32 v[186:187], v[186:187], s[60:61]
    v_cvt_pk_bf16_f32 v24, v168, v169
    v_cvt_pk_bf16_f32 v25, v170, v171
    v_cvt_pk_bf16_f32 v26, v184, v185
    v_cvt_pk_bf16_f32 v27, v186, v187
    v_cndmask_b32 v26, v26, v18, s[56:57]
    v_cndmask_b32 v27, v27, 0, s[56:57]
    buffer_store_dwordx4 v[24:27], v17, s[48:51], s12 offen offset:0 sc1
    v_pk_mul_f32 v[172:173], v[172:173], s[60:61]
    v_pk_mul_f32 v[174:175], v[174:175], s[60:61]
    v_pk_mul_f32 v[188:189], v[188:189], s[60:61]
    v_pk_mul_f32 v[190:191], v[190:191], s[60:61]
    v_cvt_pk_bf16_f32 v28, v172, v173
    v_cvt_pk_bf16_f32 v29, v174, v175
    v_cvt_pk_bf16_f32 v30, v188, v189
    v_cvt_pk_bf16_f32 v31, v190, v191
    v_cndmask_b32 v30, v30, v18, s[56:57]
    v_cndmask_b32 v31, v31, 0, s[56:57]
    buffer_store_dwordx4 v[28:31], v17, s[48:51], s12 offen offset:1024 sc1
    v_pk_mul_f32 v[176:177], v[176:177], s[60:61]
    v_pk_mul_f32 v[178:179], v[178:179], s[60:61]
    v_pk_mul_f32 v[192:193], v[192:193], s[60:61]
    v_pk_mul_f32 v[194:195], v[194:195], s[60:61]
    v_cvt_pk_bf16_f32 v32, v176, v177
    v_cvt_pk_bf16_f32 v33, v178, v179
    v_cvt_pk_bf16_f32 v34, v192, v193
    v_cvt_pk_bf16_f32 v35, v194, v195
    v_cndmask_b32 v34, v34, v18, s[56:57]
    v_cndmask_b32 v35, v35, 0, s[56:57]
    buffer_store_dwordx4 v[32:35], v17, s[48:51], s12 offen offset:2048 sc1
    v_pk_mul_f32 v[180:181], v[180:181], s[60:61]
    v_pk_mul_f32 v[182:183], v[182:183], s[60:61]
    v_pk_mul_f32 v[196:197], v[196:197], s[60:61]
    v_pk_mul_f32 v[198:199], v[198:199], s[60:61]
    v_cvt_pk_bf16_f32 v36, v180, v181
    v_cvt_pk_bf16_f32 v37, v182, v183
    v_cvt_pk_bf16_f32 v38, v196, v197
    v_cvt_pk_bf16_f32 v39, v198, v199
    v_cndmask_b32 v38, v38, v18, s[56:57]
    v_cndmask_b32 v39, v39, 0, s[56:57]
    buffer_store_dwordx4 v[36:39], v17, s[48:51], s12 offen offset:3072 sc1
    s_barrier
    s_lshl_b32 s9, s7, 4
    s_add_u32 s9, s9, s6
    s_lshl_b32 s9, s9, 2
    s_add_u32 s9, s9, s3
    s_branch g0_p1done
g0_p1b:
    s_mov_b32 s24, 7
    s_mov_b32 s25, 5
    s_mov_b32 s26, 65536
    s_mov_b32 s27, 4
    s_mov_b32 s28, 65536
    s_mov_b32 s29, 98304
    s_lshl_b32 s14, s3, 12
    s_add_u32 s14, s14, 65536
    v_and_b32 v17, 15, v1
    v_lshrrev_b32 v18, 1, v17
    v_lshrrev_b32 v14, 4, v1
    v_xor_b32 v14, v14, v18
    v_lshlrev_b32 v14, 4, v14
    v_lshl_add_u32 v14, v17, 7, v14
    v_add_u32 v14, s14, v14
    v_xor_b32 v15, 64, v14
    v_subrev_u32 v16, s14, v14
    v_add_u32 v16, 81920, v16
    v_xor_b32 v21, 64, v16
    v_mov_b32 v104, 0
    v_mov_b32 v105, 0
    v_mov_b32 v106, 0
    v_mov_b32 v107, 0
    v_mov_b32 v108, 0
    v_mov_b32 v109, 0
    v_mov_b32 v110, 0
    v_mov_b32 v111, 0
    v_mov_b32 v112, 0
    v_mov_b32 v113, 0
    v_mov_b32 v114, 0
    v_mov_b32 v115, 0
    v_mov_b32 v116, 0
    v_mov_b32 v117, 0
    v_mov_b32 v118, 0
    v_mov_b32 v119, 0
    v_mov_b32 v120, 0
    v_mov_b32 v121, 0
    v_mov_b32 v122, 0
    v_mov_b32 v123, 0
    v_mov_b32 v124, 0
    v_mov_b32 v125, 0
    v_mov_b32 v126, 0
    v_mov_b32 v127, 0
    v_mov_b32 v128, 0
    v_mov_b32 v129, 0
    v_mov_b32 v130, 0
    v_mov_b32 v131, 0
    v_mov_b32 v132, 0
    v_mov_b32 v133, 0
    v_mov_b32 v134, 0
    v_mov_b32 v135, 0
    v_mov_b32 v136, 0
    v_mov_b32 v137, 0
    v_mov_b32 v138, 0
    v_mov_b32 v139, 0
    v_mov_b32 v140, 0
    v_mov_b32 v141, 0
    v_mov_b32 v142, 0
    v_mov_b32 v143, 0
    v_mov_b32 v144, 0
    v_mov_b32 v145, 0
    v_mov_b32 v146, 0
    v_mov_b32 v147, 0
    v_mov_b32 v148, 0
    v_mov_b32 v149, 0
    v_mov_b32 v150, 0
    v_mov_b32 v151, 0
    v_mov_b32 v152, 0
    v_mov_b32 v153, 0
    v_mov_b32 v154, 0
    v_mov_b32 v155, 0
    v_mov_b32 v156, 0
    v_mov_b32 v157, 0
    v_mov_b32 v158, 0
    v_mov_b32 v159, 0
    s_mov_b32 s9, 2
    s_barrier
    ds_read_b128 v[24:27], v14 offset:0
    ds_read_b128 v[28:31], v14 offset:2048
    ds_read_b128 v[32:35], v16 offset:0
    ds_read_b128 v[36:39], v16 offset:2048
    ds_read_b128 v[40:43], v16 offset:4096
    ds_read_b128 v[44:47], v16 offset:6144
    ds_read_b128 v[48:51], v16 offset:8192
    ds_read_b128 v[52:55], v16 offset:10240
    ds_read_b128 v[56:59], v16 offset:12288
    s_mov_b32 s10, 7
bs_14:
    s_waitcnt lgkmcnt(6)
    v_mfma_f32_16x16x32_bf16 v[104:107], v[24:27], v[32:35], v[104:107]
    ds_read_b128 v[60:63], v15 offset:0
    v_mfma_f32_16x16x32_bf16 v[108:111], v[28:31], v[32:35], v[108:111]
    ds_read_b128 v[64:67], v15 offset:2048
    s_waitcnt lgkmcnt(7)
    v_mfma_f32_16x16x32_bf16 v[112:115], v[24:27], v[36:39], v[112:115]
    s_add_u32 s9, s9, 1
    s_cmp_eq_u32 s9, 5
    v_mfma_f32_16x16x32_bf16 v[116:119], v[28:31], v[36:39], v[116:119]
    ds_read_b128 v[68:71], v21 offset:0
    s_waitcnt lgkmcnt(7)
    v_mfma_f32_16x16x32_bf16 v[120:123], v[24:27], v[40:43], v[120:123]
    ds_read_b128 v[72:75], v21 offset:2048
    v_mfma_f32_16x16x32_bf16 v[124:127], v[28:31], v[40:43], v[124:127]
    s_cselect_b32 s11, -4, 1
    s_cselect_b32 s9, 0, s9
    s_waitcnt lgkmcnt(7)
    v_mfma_f32_16x16x32_bf16 v[128:131], v[24:27], v[44:47], v[128:131]
    ds_read_b128 v[76:79], v21 offset:4096
    v_mfma_f32_16x16x32_bf16 v[132:135], v[28:31], v[44:47], v[132:135]
    ds_read_b128 v[80:83], v21 offset:6144
    s_waitcnt lgkmcnt(8)
    v_mfma_f32_16x16x32_bf16 v[136:139], v[24:27], v[48:51], v[136:139]
    s_mul_i32 s11, s11, 32768
    v_mfma_f32_16x16x32_bf16 v[140:143], v[28:31], v[48:51], v[140:143]
    ds_read_b128 v[84:87], v21 offset:8192
    s_waitcnt lgkmcnt(8)
    v_mfma_f32_16x16x32_bf16 v[144:147], v[24:27], v[52:55], v[144:147]
    ds_read_b128 v[88:91], v21 offset:10240
    v_mfma_f32_16x16x32_bf16 v[148:151], v[28:31], v[52:55], v[148:151]
    v_add_u32 v14, s11, v14
    s_waitcnt lgkmcnt(8)
    v_mfma_f32_16x16x32_bf16 v[152:155], v[24:27], v[56:59], v[152:155]
    ds_read_b128 v[92:95], v21 offset:12288
    v_mfma_f32_16x16x32_bf16 v[156:159], v[28:31], v[56:59], v[156:159]
    v_add_u32 v16, s11, v16
    s_barrier
    s_waitcnt lgkmcnt(6)
    v_mfma_f32_16x16x32_bf16 v[104:107], v[60:63], v[68:71], v[104:107]
    ds_read_b128 v[24:27], v14 offset:0
    v_mfma_f32_16x16x32_bf16 v[108:111], v[64:67], v[68:71], v[108:111]
    ds_read_b128 v[28:31], v14 offset:2048
    s_waitcnt lgkmcnt(7)
    v_mfma_f32_16x16x32_bf16 v[112:115], v[60:63], v[72:75], v[112:115]
    v_add_u32 v15, s11, v15
    v_mfma_f32_16x16x32_bf16 v[116:119], v[64:67], v[72:75], v[116:119]
    ds_read_b128 v[32:35], v16 offset:0
    s_waitcnt lgkmcnt(7)
    v_mfma_f32_16x16x32_bf16 v[120:123], v[60:63], v[76:79], v[120:123]
    ds_read_b128 v[36:39], v16 offset:2048
    v_mfma_f32_16x16x32_bf16 v[124:127], v[64:67], v[76:79], v[124:127]
    v_add_u32 v21, s11, v21
    s_waitcnt lgkmcnt(7)
    v_mfma_f32_16x16x32_bf16 v[128:131], v[60:63], v[80:83], v[128:131]
    ds_read_b128 v[40:43], v16 offset:4096
    v_mfma_f32_16x16x32_bf16 v[132:135], v[64:67], v[80:83], v[132:135]
    ds_read_b128 v[44:47], v16 offset:6144
    s_waitcnt lgkmcnt(8)
    v_mfma_f32_16x16x32_bf16 v[136:139], v[60:63], v[84:87], v[136:139]
    s_sub_u32 s10, s10, 1
    s_cmp_lg_u32 s10, 0
    v_mfma_f32_16x16x32_bf16 v[140:143], v[64:67], v[84:87], v[140:143]
    ds_read_b128 v[48:51], v16 offset:8192
    s_waitcnt lgkmcnt(8)
    v_mfma_f32_16x16x32_bf16 v[144:147], v[60:63], v[88:91], v[144:147]
    ds_read_b128 v[52:55], v16 offset:10240
    v_mfma_f32_16x16x32_bf16 v[148:151], v[64:67], v[88:91], v[148:151]
    s_waitcnt lgkmcnt(8)
    v_mfma_f32_16x16x32_bf16 v[152:155], v[60:63], v[92:95], v[152:155]
    ds_read_b128 v[56:59], v16 offset:12288
    v_mfma_f32_16x16x32_bf16 v[156:159], v[64:67], v[92:95], v[156:159]
    s_cbranch_scc1 bs_14
    s_waitcnt lgkmcnt(0)
    s_mul_i32 s9, s7, 458752
    s_lshl_b32 s10, s6, 2
    s_add_u32 s10, s10, s3
    s_mul_i32 s10, s10, 7168
    s_add_u32 s9, s9, s10
    s_add_u32 s9, s9, 8388608
    s_add_u32 s10, s9, 4096
    v_lshlrev_b32 v17, 4, v1
    v_cvt_pk_bf16_f32 v24, v104, v105
    v_cvt_pk_bf16_f32 v25, v106, v107
    v_cvt_pk_bf16_f32 v26, v108, v109
    v_cvt_pk_bf16_f32 v27, v110, v111
    buffer_store_dwordx4 v[24:27], v17, s[48:51], s9 offen offset:0 sc1
    v_cvt_pk_bf16_f32 v28, v112, v113
    v_cvt_pk_bf16_f32 v29, v114, v115
    v_cvt_pk_bf16_f32 v30, v116, v117
    v_cvt_pk_bf16_f32 v31, v118, v119
    buffer_store_dwordx4 v[28:31], v17, s[48:51], s9 offen offset:1024 sc1
    v_cvt_pk_bf16_f32 v32, v120, v121
    v_cvt_pk_bf16_f32 v33, v122, v123
    v_cvt_pk_bf16_f32 v34, v124, v125
    v_cvt_pk_bf16_f32 v35, v126, v127
    buffer_store_dwordx4 v[32:35], v17, s[48:51], s9 offen offset:2048 sc1
    v_cvt_pk_bf16_f32 v36, v128, v129
    v_cvt_pk_bf16_f32 v37, v130, v131
    v_cvt_pk_bf16_f32 v38, v132, v133
    v_cvt_pk_bf16_f32 v39, v134, v135
    buffer_store_dwordx4 v[36:39], v17, s[48:51], s9 offen offset:3072 sc1
    v_cvt_pk_bf16_f32 v40, v136, v137
    v_cvt_pk_bf16_f32 v41, v138, v139
    v_cvt_pk_bf16_f32 v42, v140, v141
    v_cvt_pk_bf16_f32 v43, v142, v143
    buffer_store_dwordx4 v[40:43], v17, s[48:51], s10 offen offset:0 sc1
    v_cvt_pk_bf16_f32 v44, v144, v145
    v_cvt_pk_bf16_f32 v45, v146, v147
    v_cvt_pk_bf16_f32 v46, v148, v149
    v_cvt_pk_bf16_f32 v47, v150, v151
    buffer_store_dwordx4 v[44:47], v17, s[48:51], s10 offen offset:1024 sc1
    v_cvt_pk_bf16_f32 v48, v152, v153
    v_cvt_pk_bf16_f32 v49, v154, v155
    v_cvt_pk_bf16_f32 v50, v156, v157
    v_cvt_pk_bf16_f32 v51, v158, v159
    buffer_store_dwordx4 v[48:51], v17, s[48:51], s10 offen offset:2048 sc1
    s_lshl_b32 s9, s7, 4
    s_add_u32 s9, s9, s6
    s_add_u32 s9, s9, 128
    s_lshl_b32 s9, s9, 2
    s_add_u32 s9, s9, s3
g0_p1done:
    s_lshl_b32 s14, s3, 12
    s_add_u32 s14, s14, 131072
    v_and_b32 v17, 15, v1
    v_lshrrev_b32 v18, 1, v17
    v_lshrrev_b32 v14, 4, v1
    v_xor_b32 v14, v14, v18
    v_lshlrev_b32 v14, 4, v14
    v_lshl_add_u32 v14, v17, 7, v14
    v_add_u32 v14, s14, v14
    v_xor_b32 v15, 64, v14
    v_lshlrev_b32 v16, 4, v1
    v_add_u32 v16, 147456, v16
    v_mov_b32 v104, 0
    v_mov_b32 v105, 0
    v_mov_b32 v106, 0
    v_mov_b32 v107, 0
    v_mov_b32 v108, 0
    v_mov_b32 v109, 0
    v_mov_b32 v110, 0
    v_mov_b32 v111, 0
    v_mov_b32 v112, 0
    v_mov_b32 v113, 0
    v_mov_b32 v114, 0
    v_mov_b32 v115, 0
    v_mov_b32 v116, 0
    v_mov_b32 v117, 0
    v_mov_b32 v118, 0
    v_mov_b32 v119, 0
    v_mov_b32 v120, 0
    v_mov_b32 v121, 0
    v_mov_b32 v122, 0
    v_mov_b32 v123, 0
    v_mov_b32 v124, 0
    v_mov_b32 v125, 0
    v_mov_b32 v126, 0
    v_mov_b32 v127, 0
    v_mov_b32 v128, 0
    v_mov_b32 v129, 0
    v_mov_b32 v130, 0
    v_mov_b32 v131, 0
    v_mov_b32 v132, 0
    v_mov_b32 v133, 0
    v_mov_b32 v134, 0
    v_mov_b32 v135, 0
    v_mov_b32 v136, 0
    v_mov_b32 v137, 0
    v_mov_b32 v138, 0
    v_mov_b32 v139, 0
    v_mov_b32 v140, 0
    v_mov_b32 v141, 0
    v_mov_b32 v142, 0
    v_mov_b32 v143, 0
    v_mov_b32 v144, 0
    v_mov_b32 v145, 0
    v_mov_b32 v146, 0
    v_mov_b32 v147, 0
    v_mov_b32 v148, 0
    v_mov_b32 v149, 0
    v_mov_b32 v150, 0
    v_mov_b32 v151, 0
    v_mov_b32 v152, 0
    v_mov_b32 v153, 0
    v_mov_b32 v154, 0
    v_mov_b32 v155, 0
    v_mov_b32 v156, 0
    v_mov_b32 v157, 0
    v_mov_b32 v158, 0
    v_mov_b32 v159, 0
    s_waitcnt vmcnt(0)
    s_lshl_b32 s14, s9, 4
    s_add_u32 s14, s14, 0
    v_mov_b32 v17, 0
    v_mov_b32 v18, s38
    s_mov_b64 exec, 1
    buffer_store_dword v18, v17, s[48:51], s14 offen sc1
    s_mov_b64 exec, -1
    s_cmp_lt_u32 s5, 16
    s_cbranch_scc1 g0_t1
    s_barrier
g0_t1:
    v_and_b32 v17, 31, v1
    v_lshrrev_b32 v18, 5, v1
    v_lshlrev_b32 v18, 2, v18
    v_sub_u32 v17, v17, v18
    v_mov_b32 v18, 4048155338
    v_cmp_gt_i32 vcc, 0, v17
    s_nop 1
    v_cndmask_b32 v168, v18, 0, vcc
    v_cndmask_b32 v184, 0, v18, vcc
    v_cmp_gt_i32 vcc, 1, v17
    s_nop 1
    v_cndmask_b32 v169, v18, 0, vcc
    v_cndmask_b32 v185, 0, v18, vcc
    v_cmp_gt_i32 vcc, 2, v17
    s_nop 1
    v_cndmask_b32 v170, v18, 0, vcc
    v_cndmask_b32 v186, 0, v18, vcc
    v_cmp_gt_i32 vcc, 3, v17
    s_nop 1
    v_cndmask_b32 v171, v18, 0, vcc
    v_cndmask_b32 v187, 0, v18, vcc
    v_cmp_gt_i32 vcc, 8, v17
    s_nop 1
    v_cndmask_b32 v172, v18, 0, vcc
    v_cndmask_b32 v188, 0, v18, vcc
    v_cmp_gt_i32 vcc, 9, v17
    s_nop 1
    v_cndmask_b32 v173, v18, 0, vcc
    v_cndmask_b32 v189, 0, v18, vcc
    v_cmp_gt_i32 vcc, 10, v17
    s_nop 1
    v_cndmask_b32 v174, v18, 0, vcc
    v_cndmask_b32 v190, 0, v18, vcc
    v_cmp_gt_i32 vcc, 11, v17
    s_nop 1
    v_cndmask_b32 v175, v18, 0, vcc
    v_cndmask_b32 v191, 0, v18, vcc
    v_cmp_gt_i32 vcc, 16, v17
    s_nop 1
    v_cndmask_b32 v176, v18, 0, vcc
    v_cndmask_b32 v192, 0, v18, vcc
    v_cmp_gt_i32 vcc, 17, v17
    s_nop 1
    v_cndmask_b32 v177, v18, 0, vcc
    v_cndmask_b32 v193, 0, v18, vcc
    v_cmp_gt_i32 vcc, 18, v17
    s_nop 1
    v_cndmask_b32 v178, v18, 0, vcc
    v_cndmask_b32 v194, 0, v18, vcc
    v_cmp_gt_i32 vcc, 19, v17
    s_nop 1
    v_cndmask_b32 v179, v18, 0, vcc
    v_cndmask_b32 v195, 0, v18, vcc
    v_cmp_gt_i32 vcc, 24, v17
    s_nop 1
    v_cndmask_b32 v180, v18, 0, vcc
    v_cndmask_b32 v196, 0, v18, vcc
    v_cmp_gt_i32 vcc, 25, v17
    s_nop 1
    v_cndmask_b32 v181, v18, 0, vcc
    v_cndmask_b32 v197, 0, v18, vcc
    v_cmp_gt_i32 vcc, 26, v17
    s_nop 1
    v_cndmask_b32 v182, v18, 0, vcc
    v_cndmask_b32 v198, 0, v18, vcc
    v_cmp_gt_i32 vcc, 27, v17
    s_nop 1
    v_cndmask_b32 v183, v18, 0, vcc
    v_cndmask_b32 v199, 0, v18, vcc
    v_bfe_u32 v17, v1, 4, 1
    v_lshrrev_b32 v18, 5, v1
    v_lshlrev_b32 v17, 10, v17
    v_lshl_add_u32 v17, v18, 8, v17
    v_and_b32 v18, 15, v1
    v_lshl_add_u32 v99, v18, 4, v17
    s_lshl_b32 s14, s3, 11
    s_add_u32 s15, s14, s28
    v_add_u32 v96, s15, v99
    v_bfe_u32 v17, v1, 4, 1
    v_bfe_u32 v18, v1, 1, 1
    v_lshl_add_u32 v17, v17, 1, v18
    v_lshrrev_b32 v18, 5, v1
    v_add_u32 v18, v18, v17
    v_and_b32 v18, 3, v18
    v_lshlrev_b32 v18, 6, v18
    v_lshl_add_u32 v17, v17, 8, v18
    v_bfe_u32 v18, v1, 2, 2
    v_lshl_add_u32 v17, v18, 4, v17
    v_and_b32 v18, 1, v1
    v_lshl_add_u32 v17, v18, 3, v17
    s_add_u32 s15, s14, s29
    v_add_u32 v97, s15, v17
    v_xor_b32 v98, 128, v97
    s_lshl_b32 s15, s99, 17
    s_add_u32 s14, s14, s15
    s_lshl_b32 s15, s100, 13
    s_add_u32 s14, s14, s15
    s_add_u32 s16, s14, 12582912
    s_add_u32 s23, s14, 1048576
    s_lshl_b32 s17, s100, 1
    s_lshr_b32 s14, s3, 1
    s_add_u32 s17, s17, s14
    s_lshl_b32 s17, s17, 4
    s_add_u32 s17, s17, s99
    s_lshl_b32 s17, s17, 1
    s_and_b32 s14, s3, 1
    s_add_u32 s17, s17, s14
    s_mov_b32 s18, 0
    s_mov_b32 s19, -1
    s_cmp_lt_u32 s5, 16
    s_cbranch_scc1 g0_t2
    s_cmp_lg_u32 s3, 0
    s_cbranch_scc1 g0_nopoll
    s_lshr_b32 s15, s98, 1
    s_lshl_b32 s15, s15, 2
    s_add_u32 s15, s15, s97
    s_lshl_b32 s15, s15, 4
    s_and_b32 s14, s98, 1
    s_lshl_b32 s14, s14, 3
    s_add_u32 s15, s15, s14
    s_add_u32 s15, s15, 128
    s_lshl_b32 s56, s15, 6
    v_and_b32 v17, 31, v1
    v_lshlrev_b32 v17, 4, v17
    s_mov_b32 s39, 0
pab_15:
    buffer_load_dword v18, v17, s[48:51], s56 offen sc1
    s_add_u32 s39, s39, 1
    s_waitcnt vmcnt(0)
    v_cmp_ne_u32 vcc, s38, v18
    s_cmp_ge_u32 s39, 20000
    s_cbranch_scc1 pab_15_x
    s_cbranch_vccz pab_15_x
    s_sleep 4
    s_branch pab_15
pab_15_x:
g0_nopoll:
    s_barrier
g0_t2:
    s_mov_b32 s8, 4
    s_barrier
    ds_read_b128 v[24:27], v14 offset:0
    ds_read_b128 v[28:31], v14 offset:2048
    ds_read_b128 v[32:35], v16 offset:0
    ds_read_b128 v[36:39], v16 offset:1024
    ds_read_b128 v[40:43], v16 offset:2048
    ds_read_b128 v[44:47], v16 offset:3072
    ds_read_b128 v[48:51], v16 offset:4096
    ds_read_b128 v[52:55], v16 offset:5120
    ds_read_b128 v[56:59], v16 offset:6144
    s_mov_b32 s10, s24
bb1_16:
    s_waitcnt lgkmcnt(6)
    v_mfma_f32_16x16x32_bf16 v[104:107], v[32:35], v[24:27], v[104:107]
    ds_read_b128 v[60:63], v15 offset:0
    v_mfma_f32_16x16x32_bf16 v[108:111], v[32:35], v[28:31], v[108:111]
    ds_read_b128 v[64:67], v15 offset:2048
    s_waitcnt lgkmcnt(7)
    v_mfma_f32_16x16x32_bf16 v[112:115], v[36:39], v[24:27], v[112:115]
    s_add_u32 s8, s8, 1
    s_cmp_eq_u32 s8, 5
    v_mfma_f32_16x16x32_bf16 v[116:119], v[36:39], v[28:31], v[116:119]
    ds_read_b128 v[68:71], v16 offset:7168
    s_waitcnt lgkmcnt(7)
    v_mfma_f32_16x16x32_bf16 v[120:123], v[40:43], v[24:27], v[120:123]
    ds_read_b128 v[72:75], v16 offset:8192
    v_mfma_f32_16x16x32_bf16 v[124:127], v[40:43], v[28:31], v[124:127]
    s_cselect_b32 s11, -4, 1
    s_cselect_b32 s8, 0, s8
    s_waitcnt lgkmcnt(7)
    v_mfma_f32_16x16x32_bf16 v[128:131], v[44:47], v[24:27], v[128:131]
    ds_read_b128 v[76:79], v16 offset:9216
    v_mfma_f32_16x16x32_bf16 v[132:135], v[44:47], v[28:31], v[132:135]
    ds_read_b128 v[80:83], v16 offset:10240
    s_waitcnt lgkmcnt(8)
    v_mfma_f32_16x16x32_bf16 v[136:139], v[48:51], v[24:27], v[136:139]
    s_mul_i32 s11, s11, 32768
    v_mfma_f32_16x16x32_bf16 v[140:143], v[48:51], v[28:31], v[140:143]
    ds_read_b128 v[84:87], v16 offset:11264
    s_waitcnt lgkmcnt(8)
    v_mfma_f32_16x16x32_bf16 v[144:147], v[52:55], v[24:27], v[144:147]
    ds_read_b128 v[88:91], v16 offset:12288
    v_mfma_f32_16x16x32_bf16 v[148:151], v[52:55], v[28:31], v[148:151]
    v_add_u32 v14, s11, v14
    s_waitcnt lgkmcnt(8)
    v_mfma_f32_16x16x32_bf16 v[152:155], v[56:59], v[24:27], v[152:155]
    ds_read_b128 v[92:95], v16 offset:13312
    v_mfma_f32_16x16x32_bf16 v[156:159], v[56:59], v[28:31], v[156:159]
    v_add_u32 v16, s11, v16
    s_barrier
    s_waitcnt lgkmcnt(6)
    v_mfma_f32_16x16x32_bf16 v[104:107], v[68:71], v[60:63], v[104:107]
    ds_read_b128 v[24:27], v14 offset:0
    v_mfma_f32_16x16x32_bf16 v[108:111], v[68:71], v[64:67], v[108:111]
    ds_read_b128 v[28:31], v14 offset:2048
    s_waitcnt lgkmcnt(7)
    v_mfma_f32_16x16x32_bf16 v[112:115], v[72:75], v[60:63], v[112:115]
    v_add_u32 v15, s11, v15
    v_mfma_f32_16x16x32_bf16 v[116:119], v[72:75], v[64:67], v[116:119]
    ds_read_b128 v[32:35], v16 offset:0
    s_waitcnt lgkmcnt(7)
    v_mfma_f32_16x16x32_bf16 v[120:123], v[76:79], v[60:63], v[120:123]
    ds_read_b128 v[36:39], v16 offset:1024
    v_mfma_f32_16x16x32_bf16 v[124:127], v[76:79], v[64:67], v[124:127]
    s_sub_u32 s10, s10, 1
    s_cmp_lg_u32 s10, 0
    s_waitcnt lgkmcnt(7)
    v_mfma_f32_16x16x32_bf16 v[128:131], v[80:83], v[60:63], v[128:131]
    ds_read_b128 v[40:43], v16 offset:2048
    v_mfma_f32_16x16x32_bf16 v[132:135], v[80:83], v[64:67], v[132:135]
    ds_read_b128 v[44:47], v16 offset:3072
    s_waitcnt lgkmcnt(8)
    v_mfma_f32_16x16x32_bf16 v[136:139], v[84:87], v[60:63], v[136:139]
    v_mfma_f32_16x16x32_bf16 v[140:143], v[84:87], v[64:67], v[140:143]
    ds_read_b128 v[48:51], v16 offset:4096
    s_waitcnt lgkmcnt(8)
    v_mfma_f32_16x16x32_bf16 v[144:147], v[88:91], v[60:63], v[144:147]
    ds_read_b128 v[52:55], v16 offset:5120
    v_mfma_f32_16x16x32_bf16 v[148:151], v[88:91], v[64:67], v[148:151]
    s_waitcnt lgkmcnt(8)
    v_mfma_f32_16x16x32_bf16 v[152:155], v[92:95], v[60:63], v[152:155]
    ds_read_b128 v[56:59], v16 offset:6144
    v_mfma_f32_16x16x32_bf16 v[156:159], v[92:95], v[64:67], v[156:159]
    s_cbranch_scc1 bb1_16
    buffer_load_dwordx4 v[160:163], v99, s[48:51], s23 offen sc1
    buffer_load_dwordx4 v[164:167], v99, s[48:51], s23 offen offset:512 sc1
    s_mov_b32 s10, 1
bb1b_17:
    s_waitcnt lgkmcnt(6)
    v_mfma_f32_16x16x32_bf16 v[104:107], v[32:35], v[24:27], v[104:107]
    ds_read_b128 v[60:63], v15 offset:0
    v_mfma_f32_16x16x32_bf16 v[108:111], v[32:35], v[28:31], v[108:111]
    ds_read_b128 v[64:67], v15 offset:2048
    s_waitcnt lgkmcnt(7)
    v_mfma_f32_16x16x32_bf16 v[112:115], v[36:39], v[24:27], v[112:115]
    ds_read_b128 v[68:71], v16 offset:7168
    v_mfma_f32_16x16x32_bf16 v[116:119], v[36:39], v[28:31], v[116:119]
    ds_read_b128 v[72:75], v16 offset:8192
    s_waitcnt lgkmcnt(8)
    v_mfma_f32_16x16x32_bf16 v[120:123], v[40:43], v[24:27], v[120:123]
    ds_read_b128 v[76:79], v16 offset:9216
    v_mfma_f32_16x16x32_bf16 v[124:127], v[40:43], v[28:31], v[124:127]
    ds_read_b128 v[80:83], v16 offset:10240
    s_waitcnt lgkmcnt(9)
    v_mfma_f32_16x16x32_bf16 v[128:131], v[44:47], v[24:27], v[128:131]
    ds_read_b128 v[84:87], v16 offset:11264
    v_mfma_f32_16x16x32_bf16 v[132:135], v[44:47], v[28:31], v[132:135]
    ds_read_b128 v[88:91], v16 offset:12288
    s_waitcnt lgkmcnt(10)
    v_mfma_f32_16x16x32_bf16 v[136:139], v[48:51], v[24:27], v[136:139]
    ds_read_b128 v[92:95], v16 offset:13312
    v_mfma_f32_16x16x32_bf16 v[140:143], v[48:51], v[28:31], v[140:143]
    s_add_u32 s8, s8, 1
    s_cmp_eq_u32 s8, 5
    s_waitcnt lgkmcnt(10)
    v_mfma_f32_16x16x32_bf16 v[144:147], v[52:55], v[24:27], v[144:147]
    s_cselect_b32 s11, -4, 1
    s_cselect_b32 s8, 0, s8
    v_mfma_f32_16x16x32_bf16 v[148:151], v[52:55], v[28:31], v[148:151]
    s_mul_i32 s11, s11, 32768
    s_waitcnt lgkmcnt(9)
    v_mfma_f32_16x16x32_bf16 v[152:155], v[56:59], v[24:27], v[152:155]
    v_add_u32 v14, s11, v14
    v_mfma_f32_16x16x32_bf16 v[156:159], v[56:59], v[28:31], v[156:159]
    v_add_u32 v16, s11, v16
    s_waitcnt lgkmcnt(0)
    s_barrier
    s_waitcnt lgkmcnt(6)
    v_mfma_f32_16x16x32_bf16 v[104:107], v[68:71], v[60:63], v[104:107]
    v_add_u32 v15, s11, v15
    v_mfma_f32_16x16x32_bf16 v[108:111], v[68:71], v[64:67], v[108:111]
    s_sub_u32 s10, s10, 1
    s_cmp_lg_u32 s10, 0
    s_waitcnt lgkmcnt(5)
    v_mfma_f32_16x16x32_bf16 v[112:115], v[72:75], v[60:63], v[112:115]
    v_mfma_f32_16x16x32_bf16 v[116:119], v[72:75], v[64:67], v[116:119]
    s_waitcnt lgkmcnt(4)
    v_mfma_f32_16x16x32_bf16 v[120:123], v[76:79], v[60:63], v[120:123]
    v_mfma_f32_16x16x32_bf16 v[124:127], v[76:79], v[64:67], v[124:127]
    s_waitcnt lgkmcnt(3)
    v_mfma_f32_16x16x32_bf16 v[128:131], v[80:83], v[60:63], v[128:131]
    v_mfma_f32_16x16x32_bf16 v[132:135], v[80:83], v[64:67], v[132:135]
    s_waitcnt lgkmcnt(2)
    v_mfma_f32_16x16x32_bf16 v[136:139], v[84:87], v[60:63], v[136:139]
    v_mfma_f32_16x16x32_bf16 v[140:143], v[84:87], v[64:67], v[140:143]
    s_waitcnt lgkmcnt(1)
    v_mfma_f32_16x16x32_bf16 v[144:147], v[88:91], v[60:63], v[144:147]
    v_mfma_f32_16x16x32_bf16 v[148:151], v[88:91], v[64:67], v[148:151]
    s_waitcnt lgkmcnt(0)
    v_mfma_f32_16x16x32_bf16 v[152:155], v[92:95], v[60:63], v[152:155]
    v_mfma_f32_16x16x32_bf16 v[156:159], v[92:95], v[64:67], v[156:159]
    s_cbranch_scc1 bb1b_17
    v_add_u32 v14, s26, v14
    v_add_u32 v15, s26, v15
    v_add_u32 v16, s26, v16
    s_mov_b32 s8, s27
    s_waitcnt vmcnt(0)
    ds_read_b128 v[76:79], v96 offset:0
    ds_read_b128 v[80:83], v96 offset:512
    ds_read_b128 v[84:87], v96 offset:2048
    ds_read_b128 v[88:91], v96 offset:2560
    ds_read_b128 v[24:27], v96 offset:4096
    ds_read_b128 v[28:31], v96 offset:4608
    v_mov_b32 v56, 4048155338
    v_mov_b32 v57, 4048155338
    s_waitcnt lgkmcnt(4)
    v_mfma_f32_32x32x16_bf16 v[232:247], v[76:79], v[160:163], v[168:183]
    ds_read_b128 v[32:35], v96 offset:6144
    v_mfma_f32_32x32x16_bf16 v[232:247], v[80:83], v[164:167], v[232:247]
    ds_read_b128 v[36:39], v96 offset:6656
    s_waitcnt lgkmcnt(4)
    v_mfma_f32_32x32x16_bf16 v[60:75], v[84:87], v[160:163], 0
    ds_read_b128 v[76:79], v96 offset:8192
    v_mfma_f32_32x32x16_bf16 v[60:75], v[88:91], v[164:167], v[60:75]
    ds_read_b128 v[80:83], v96 offset:8704
    s_nop 4
    s_waitcnt lgkmcnt(4)
    v_mfma_f32_32x32x16_bf16 v[216:231], v[24:27], v[160:163], 0
    v_max3_f32 v56, v232, v233, v56
    v_max3_f32 v57, v234, v235, v57
    v_max3_f32 v56, v236, v237, v56
    v_max3_f32 v57, v238, v239, v57
    ds_read_b128 v[84:87], v96 offset:10240
    v_mfma_f32_32x32x16_bf16 v[216:231], v[28:31], v[164:167], v[216:231]
    v_max3_f32 v56, v240, v241, v56
    v_max3_f32 v57, v242, v243, v57
    v_max3_f32 v56, v244, v245, v56
    v_max3_f32 v57, v246, v247, v57
    ds_read_b128 v[88:91], v96 offset:10752
    s_waitcnt lgkmcnt(4)
    v_mfma_f32_32x32x16_bf16 v[232:247], v[32:35], v[160:163], 0
    v_max3_f32 v56, v60, v61, v56
    v_max3_f32 v57, v62, v63, v57
    v_max3_f32 v56, v64, v65, v56
    v_max3_f32 v57, v66, v67, v57
    ds_read_b128 v[24:27], v96 offset:12288
    v_mfma_f32_32x32x16_bf16 v[232:247], v[36:39], v[164:167], v[232:247]
    v_max3_f32 v56, v68, v69, v56
    v_max3_f32 v57, v70, v71, v57
    v_max3_f32 v56, v72, v73, v56
    v_max3_f32 v57, v74, v75, v57
    ds_read_b128 v[28:31], v96 offset:12800
    s_waitcnt lgkmcnt(4)
    v_mfma_f32_32x32x16_bf16 v[60:75], v[76:79], v[160:163], 0
    v_max3_f32 v56, v216, v217, v56
    v_max3_f32 v57, v218, v219, v57
    v_max3_f32 v56, v220, v221, v56
    v_max3_f32 v57, v222, v223, v57
    ds_read_b128 v[32:35], v96 offset:14336
    v_mfma_f32_32x32x16_bf16 v[60:75], v[80:83], v[164:167], v[60:75]
    v_max3_f32 v56, v224, v225, v56
    v_max3_f32 v57, v226, v227, v57
    v_max3_f32 v56, v228, v229, v56
    v_max3_f32 v57, v230, v231, v57
    ds_read_b128 v[36:39], v96 offset:14848
    s_waitcnt lgkmcnt(4)
    v_mfma_f32_32x32x16_bf16 v[216:231], v[84:87], v[160:163], 0
    v_max3_f32 v56, v232, v233, v56
    v_max3_f32 v57, v234, v235, v57
    v_max3_f32 v56, v236, v237, v56
    v_max3_f32 v57, v238, v239, v57
    ds_read_b128 v[76:79], v96 offset:16384
    v_mfma_f32_32x32x16_bf16 v[216:231], v[88:91], v[164:167], v[216:231]
    v_max3_f32 v56, v240, v241, v56
    v_max3_f32 v57, v242, v243, v57
    v_max3_f32 v56, v244, v245, v56
    v_max3_f32 v57, v246, v247, v57
    ds_read_b128 v[80:83], v96 offset:16896
    s_waitcnt lgkmcnt(4)
    v_mfma_f32_32x32x16_bf16 v[232:247], v[24:27], v[160:163], 0
    v_max3_f32 v56, v60, v61, v56
    v_max3_f32 v57, v62, v63, v57
    v_max3_f32 v56, v64, v65, v56
    v_max3_f32 v57, v66, v67, v57
    v_mfma_f32_32x32x16_bf16 v[232:247], v[28:31], v[164:167], v[232:247]
    v_max3_f32 v56, v68, v69, v56
    v_max3_f32 v57, v70, v71, v57
    v_max3_f32 v56, v72, v73, v56
    v_max3_f32 v57, v74, v75, v57
    s_waitcnt lgkmcnt(2)
    v_mfma_f32_32x32x16_bf16 v[60:75], v[32:35], v[160:163], 0
    v_max3_f32 v56, v216, v217, v56
    v_max3_f32 v57, v218, v219, v57
    v_max3_f32 v56, v220, v221, v56
    v_max3_f32 v57, v222, v223, v57
    v_mfma_f32_32x32x16_bf16 v[60:75], v[36:39], v[164:167], v[60:75]
    v_max3_f32 v56, v224, v225, v56
    v_max3_f32 v57, v226, v227, v57
    v_max3_f32 v56, v228, v229, v56
    v_max3_f32 v57, v230, v231, v57
    s_waitcnt lgkmcnt(0)
    v_mfma_f32_32x32x16_bf16 v[216:231], v[76:79], v[160:163], v[184:199]
    v_max3_f32 v56, v232, v233, v56
    v_max3_f32 v57, v234, v235, v57
    v_max3_f32 v56, v236, v237, v56
    v_max3_f32 v57, v238, v239, v57
    v_mfma_f32_32x32x16_bf16 v[216:231], v[80:83], v[164:167], v[216:231]
    v_max3_f32 v56, v240, v241, v56
    v_max3_f32 v57, v242, v243, v57
    v_max3_f32 v56, v244, v245, v56
    v_max3_f32 v57, v246, v247, v57
    ds_read_b128 v[76:79], v96 offset:0
    ds_read_b128 v[80:83], v96 offset:512
    ds_read_b128 v[84:87], v96 offset:2048
    ds_read_b128 v[88:91], v96 offset:2560
    v_max3_f32 v56, v60, v61, v56
    v_max3_f32 v57, v62, v63, v57
    v_max3_f32 v56, v64, v65, v56
    v_max3_f32 v57, v66, v67, v57
    v_max3_f32 v56, v68, v69, v56
    v_max3_f32 v57, v70, v71, v57
    v_max3_f32 v56, v72, v73, v56
    v_max3_f32 v57, v74, v75, v57
    ds_read_b64_tr_b16 v[40:41], v97 offset:0
    ds_read_b64_tr_b16 v[42:43], v98 offset:0
    ds_read_b64_tr_b16 v[44:45], v97 offset:1024
    ds_read_b64_tr_b16 v[46:47], v98 offset:1024
    v_max3_f32 v56, v216, v217, v56
    v_max3_f32 v57, v218, v219, v57
    v_max3_f32 v56, v220, v221, v56
    v_max3_f32 v57, v222, v223, v57
    v_max3_f32 v56, v224, v225, v56
    v_max3_f32 v57, v226, v227, v57
    v_max3_f32 v56, v228, v229, v56
    v_max3_f32 v57, v230, v231, v57
    v_max_f32 v56, v56, v57
    v_mov_b32 v57, v56
    s_nop 1
    v_permlane32_swap_b32 v56, v57
    v_max_f32 v56, v56, v57
    v_sub_f32 v200, 0, v56
    v_sub_f32 v201, 0, v56
    v_pk_add_f32 v[168:169], v[168:169], v[200:201]
    v_pk_add_f32 v[170:171], v[170:171], v[200:201]
    v_pk_add_f32 v[172:173], v[172:173], v[200:201]
    v_pk_add_f32 v[174:175], v[174:175], v[200:201]
    v_pk_add_f32 v[176:177], v[176:177], v[200:201]
    v_pk_add_f32 v[178:179], v[178:179], v[200:201]
    v_pk_add_f32 v[180:181], v[180:181], v[200:201]
    v_pk_add_f32 v[182:183], v[182:183], v[200:201]
    s_waitcnt lgkmcnt(0)
    s_nop 0
    v_mfma_f32_32x32x16_bf16 v[232:247], v[76:79], v[160:163], v[168:183]
    v_pk_mov_b32 v[202:203], v[200:201], v[200:201]
    v_pk_mov_b32 v[204:205], v[200:201], v[200:201]
    v_pk_mov_b32 v[206:207], v[200:201], v[200:201]
    v_pk_mov_b32 v[208:209], v[200:201], v[200:201]
    v_pk_mov_b32 v[210:211], v[200:201], v[200:201]
    v_pk_mov_b32 v[212:213], v[200:201], v[200:201]
    v_pk_mov_b32 v[214:215], v[200:201], v[200:201]
    v_mfma_f32_32x32x16_bf16 v[232:247], v[80:83], v[164:167], v[232:247]
    v_pk_add_f32 v[184:185], v[184:185], v[200:201]
    v_pk_add_f32 v[186:187], v[186:187], v[200:201]
    v_pk_add_f32 v[188:189], v[188:189], v[200:201]
    v_pk_add_f32 v[190:191], v[190:191], v[200:201]
    v_pk_add_f32 v[192:193], v[192:193], v[200:201]
    v_pk_add_f32 v[194:195], v[194:195], v[200:201]
    v_pk_add_f32 v[196:197], v[196:197], v[200:201]
    v_pk_add_f32 v[198:199], v[198:199], v[200:201]
    s_nop 3
    v_exp_f32 v232, v232
    v_exp_f32 v233, v233
    v_exp_f32 v234, v234
    v_exp_f32 v235, v235
    v_exp_f32 v236, v236
    v_exp_f32 v237, v237
    s_waitcnt lgkmcnt(0)
    v_mfma_f32_32x32x16_bf16 v[60:75], v[84:87], v[160:163], v[200:215]
    v_exp_f32 v238, v238
    v_exp_f32 v239, v239
    v_exp_f32 v240, v240
    v_cvt_pk_bf16_f32 v248, v232, v233
    v_cvt_pk_bf16_f32 v249, v234, v235
    v_cvt_pk_bf16_f32 v250, v236, v237
    v_cvt_pk_bf16_f32 v251, v238, v239
    v_mfma_f32_32x32x16_bf16 v[60:75], v[88:91], v[164:167], v[60:75]
    ds_read_b64_tr_b16 v[48:49], v97 offset:2048
    ds_read_b64_tr_b16 v[50:51], v98 offset:2048
    ds_read_b64_tr_b16 v[52:53], v97 offset:3072
    ds_read_b64_tr_b16 v[54:55], v98 offset:3072
    v_exp_f32 v241, v241
    v_exp_f32 v242, v242
    v_exp_f32 v243, v243
    v_mfma_f32_32x32x16_bf16 v[216:231], v[40:43], v[248:251], 0
    ds_read_b128 v[76:79], v96 offset:4096
    ds_read_b128 v[80:83], v96 offset:4608
    v_exp_f32 v244, v244
    v_exp_f32 v245, v245
    v_exp_f32 v246, v246
    v_exp_f32 v247, v247
    v_cvt_pk_bf16_f32 v252, v240, v241
    v_cvt_pk_bf16_f32 v253, v242, v243
    v_cvt_pk_bf16_f32 v254, v244, v245
    v_cvt_pk_bf16_f32 v255, v246, v247
    v_exp_f32 v60, v60
    v_exp_f32 v61, v61
    v_mfma_f32_32x32x16_bf16 v[216:231], v[44:47], v[252:255], v[216:231]
    v_exp_f32 v62, v62
    v_exp_f32 v63, v63
    v_exp_f32 v64, v64
    v_exp_f32 v65, v65
    s_waitcnt lgkmcnt(0)
    v_mfma_f32_32x32x16_bf16 v[232:247], v[76:79], v[160:163], v[200:215]
    v_exp_f32 v66, v66
    v_exp_f32 v67, v67
    v_exp_f32 v68, v68
    v_cvt_pk_bf16_f32 v248, v60, v61
    v_cvt_pk_bf16_f32 v249, v62, v63
    v_cvt_pk_bf16_f32 v250, v64, v65
    v_cvt_pk_bf16_f32 v251, v66, v67
    v_mfma_f32_32x32x16_bf16 v[232:247], v[80:83], v[164:167], v[232:247]
    ds_read_b64_tr_b16 v[40:41], v97 offset:4096
    ds_read_b64_tr_b16 v[42:43], v98 offset:4096
    ds_read_b64_tr_b16 v[44:45], v97 offset:5120
    ds_read_b64_tr_b16 v[46:47], v98 offset:5120
    v_exp_f32 v69, v69
    v_exp_f32 v70, v70
    v_exp_f32 v71, v71
    v_mfma_f32_32x32x16_bf16 v[216:231], v[48:51], v[248:251], v[216:231]
    ds_read_b128 v[84:87], v96 offset:6144
    ds_read_b128 v[88:91], v96 offset:6656
    v_exp_f32 v72, v72
    v_exp_f32 v73, v73
    v_exp_f32 v74, v74
    v_exp_f32 v75, v75
    v_cvt_pk_bf16_f32 v252, v68, v69
    v_cvt_pk_bf16_f32 v253, v70, v71
    v_cvt_pk_bf16_f32 v254, v72, v73
    v_cvt_pk_bf16_f32 v255, v74, v75
    v_exp_f32 v232, v232
    v_exp_f32 v233, v233
    v_mfma_f32_32x32x16_bf16 v[216:231], v[52:55], v[252:255], v[216:231]
    v_exp_f32 v234, v234
    v_exp_f32 v235, v235
    v_exp_f32 v236, v236
    v_exp_f32 v237, v237
    s_waitcnt lgkmcnt(0)
    v_mfma_f32_32x32x16_bf16 v[60:75], v[84:87], v[160:163], v[200:215]
    v_exp_f32 v238, v238
    v_exp_f32 v239, v239
    v_exp_f32 v240, v240
    v_cvt_pk_bf16_f32 v248, v232, v233
    v_cvt_pk_bf16_f32 v249, v234, v235
    v_cvt_pk_bf16_f32 v250, v236, v237
    v_cvt_pk_bf16_f32 v251, v238, v239
    v_mfma_f32_32x32x16_bf16 v[60:75], v[88:91], v[164:167], v[60:75]
    ds_read_b64_tr_b16 v[48:49], v97 offset:6144
    ds_read_b64_tr_b16 v[50:51], v98 offset:6144
    ds_read_b64_tr_b16 v[52:53], v97 offset:7168
    ds_read_b64_tr_b16 v[54:55], v98 offset:7168
    v_exp_f32 v241, v241
    v_exp_f32 v242, v242
    v_exp_f32 v243, v243
    v_mfma_f32_32x32x16_bf16 v[216:231], v[40:43], v[248:251], v[216:231]
    ds_read_b128 v[76:79], v96 offset:8192
    ds_read_b128 v[80:83], v96 offset:8704
    v_exp_f32 v244, v244
    v_exp_f32 v245, v245
    v_exp_f32 v246, v246
    v_exp_f32 v247, v247
    v_cvt_pk_bf16_f32 v252, v240, v241
    v_cvt_pk_bf16_f32 v253, v242, v243
    v_cvt_pk_bf16_f32 v254, v244, v245
    v_cvt_pk_bf16_f32 v255, v246, v247
    v_exp_f32 v60, v60
    v_exp_f32 v61, v61
    v_mfma_f32_32x32x16_bf16 v[216:231], v[44:47], v[252:255], v[216:231]
    v_exp_f32 v62, v62
    v_exp_f32 v63, v63
    v_exp_f32 v64, v64
    v_exp_f32 v65, v65
    s_waitcnt lgkmcnt(0)
    v_mfma_f32_32x32x16_bf16 v[232:247], v[76:79], v[160:163], v[200:215]
    v_exp_f32 v66, v66
    v_exp_f32 v67, v67
    v_exp_f32 v68, v68
    v_cvt_pk_bf16_f32 v248, v60, v61
    v_cvt_pk_bf16_f32 v249, v62, v63
    v_cvt_pk_bf16_f32 v250, v64, v65
    v_cvt_pk_bf16_f32 v251, v66, v67
    v_mfma_f32_32x32x16_bf16 v[232:247], v[80:83], v[164:167], v[232:247]
    ds_read_b64_tr_b16 v[40:41], v97 offset:8192
    ds_read_b64_tr_b16 v[42:43], v98 offset:8192
    ds_read_b64_tr_b16 v[44:45], v97 offset:9216
    ds_read_b64_tr_b16 v[46:47], v98 offset:9216
    v_exp_f32 v69, v69
    v_exp_f32 v70, v70
    v_exp_f32 v71, v71
    v_mfma_f32_32x32x16_bf16 v[216:231], v[48:51], v[248:251], v[216:231]
    ds_read_b128 v[84:87], v96 offset:10240
    ds_read_b128 v[88:91], v96 offset:10752
    v_exp_f32 v72, v72
    v_exp_f32 v73, v73
    v_exp_f32 v74, v74
    v_exp_f32 v75, v75
    v_cvt_pk_bf16_f32 v252, v68, v69
    v_cvt_pk_bf16_f32 v253, v70, v71
    v_cvt_pk_bf16_f32 v254, v72, v73
    v_cvt_pk_bf16_f32 v255, v74, v75
    v_exp_f32 v232, v232
    v_exp_f32 v233, v233
    v_mfma_f32_32x32x16_bf16 v[216:231], v[52:55], v[252:255], v[216:231]
    v_exp_f32 v234, v234
    v_exp_f32 v235, v235
    v_exp_f32 v236, v236
    v_exp_f32 v237, v237
    s_waitcnt lgkmcnt(0)
    v_mfma_f32_32x32x16_bf16 v[60:75], v[84:87], v[160:163], v[200:215]
    v_exp_f32 v238, v238
    v_exp_f32 v239, v239
    v_exp_f32 v240, v240
    v_cvt_pk_bf16_f32 v248, v232, v233
    v_cvt_pk_bf16_f32 v249, v234, v235
    v_cvt_pk_bf16_f32 v250, v236, v237
    v_cvt_pk_bf16_f32 v251, v238, v239
    v_mfma_f32_32x32x16_bf16 v[60:75], v[88:91], v[164:167], v[60:75]
    ds_read_b64_tr_b16 v[48:49], v97 offset:10240
    ds_read_b64_tr_b16 v[50:51], v98 offset:10240
    ds_read_b64_tr_b16 v[52:53], v97 offset:11264
    ds_read_b64_tr_b16 v[54:55], v98 offset:11264
    v_exp_f32 v241, v241
    v_exp_f32 v242, v242
    v_exp_f32 v243, v243
    v_mfma_f32_32x32x16_bf16 v[216:231], v[40:43], v[248:251], v[216:231]
    ds_read_b128 v[76:79], v96 offset:12288
    ds_read_b128 v[80:83], v96 offset:12800
    v_exp_f32 v244, v244
    v_exp_f32 v245, v245
    v_exp_f32 v246, v246
    v_exp_f32 v247, v247
    v_cvt_pk_bf16_f32 v252, v240, v241
    v_cvt_pk_bf16_f32 v253, v242, v243
    v_cvt_pk_bf16_f32 v254, v244, v245
    v_cvt_pk_bf16_f32 v255, v246, v247
    v_exp_f32 v60, v60
    v_exp_f32 v61, v61
    v_mfma_f32_32x32x16_bf16 v[216:231], v[44:47], v[252:255], v[216:231]
    v_exp_f32 v62, v62
    v_exp_f32 v63, v63
    v_exp_f32 v64, v64
    v_exp_f32 v65, v65
    s_waitcnt lgkmcnt(0)
    v_mfma_f32_32x32x16_bf16 v[232:247], v[76:79], v[160:163], v[200:215]
    v_exp_f32 v66, v66
    v_exp_f32 v67, v67
    v_exp_f32 v68, v68
    v_cvt_pk_bf16_f32 v248, v60, v61
    v_cvt_pk_bf16_f32 v249, v62, v63
    v_cvt_pk_bf16_f32 v250, v64, v65
    v_cvt_pk_bf16_f32 v251, v66, v67
    v_mfma_f32_32x32x16_bf16 v[232:247], v[80:83], v[164:167], v[232:247]
    ds_read_b64_tr_b16 v[40:41], v97 offset:12288
    ds_read_b64_tr_b16 v[42:43], v98 offset:12288
    ds_read_b64_tr_b16 v[44:45], v97 offset:13312
    ds_read_b64_tr_b16 v[46:47], v98 offset:13312
    v_exp_f32 v69, v69
    v_exp_f32 v70, v70
    v_exp_f32 v71, v71
    v_mfma_f32_32x32x16_bf16 v[216:231], v[48:51], v[248:251], v[216:231]
    ds_read_b128 v[84:87], v96 offset:14336
    ds_read_b128 v[88:91], v96 offset:14848
    v_exp_f32 v72, v72
    v_exp_f32 v73, v73
    v_exp_f32 v74, v74
    v_exp_f32 v75, v75
    v_cvt_pk_bf16_f32 v252, v68, v69
    v_cvt_pk_bf16_f32 v253, v70, v71
    v_cvt_pk_bf16_f32 v254, v72, v73
    v_cvt_pk_bf16_f32 v255, v74, v75
    v_exp_f32 v232, v232
    v_exp_f32 v233, v233
    v_mfma_f32_32x32x16_bf16 v[216:231], v[52:55], v[252:255], v[216:231]
    v_exp_f32 v234, v234
    v_exp_f32 v235, v235
    v_exp_f32 v236, v236
    v_exp_f32 v237, v237
    s_waitcnt lgkmcnt(0)
    v_mfma_f32_32x32x16_bf16 v[60:75], v[84:87], v[160:163], v[200:215]
    v_exp_f32 v238, v238
    v_exp_f32 v239, v239
    v_exp_f32 v240, v240
    v_cvt_pk_bf16_f32 v248, v232, v233
    v_cvt_pk_bf16_f32 v249, v234, v235
    v_cvt_pk_bf16_f32 v250, v236, v237
    v_cvt_pk_bf16_f32 v251, v238, v239
    v_mfma_f32_32x32x16_bf16 v[60:75], v[88:91], v[164:167], v[60:75]
    ds_read_b64_tr_b16 v[48:49], v97 offset:14336
    ds_read_b64_tr_b16 v[50:51], v98 offset:14336
    ds_read_b64_tr_b16 v[52:53], v97 offset:15360
    ds_read_b64_tr_b16 v[54:55], v98 offset:15360
    v_exp_f32 v241, v241
    v_exp_f32 v242, v242
    v_exp_f32 v243, v243
    v_mfma_f32_32x32x16_bf16 v[216:231], v[40:43], v[248:251], v[216:231]
    ds_read_b128 v[76:79], v96 offset:16384
    ds_read_b128 v[80:83], v96 offset:16896
    v_exp_f32 v244, v244
    v_exp_f32 v245, v245
    v_exp_f32 v246, v246
    v_exp_f32 v247, v247
    v_cvt_pk_bf16_f32 v252, v240, v241
    v_cvt_pk_bf16_f32 v253, v242, v243
    v_cvt_pk_bf16_f32 v254, v244, v245
    v_cvt_pk_bf16_f32 v255, v246, v247
    v_exp_f32 v60, v60
    v_exp_f32 v61, v61
    v_mfma_f32_32x32x16_bf16 v[216:231], v[44:47], v[252:255], v[216:231]
    v_exp_f32 v62, v62
    v_exp_f32 v63, v63
    v_exp_f32 v64, v64
    v_exp_f32 v65, v65
    s_waitcnt lgkmcnt(0)
    v_mfma_f32_32x32x16_bf16 v[232:247], v[76:79], v[160:163], v[184:199]
    v_exp_f32 v66, v66
    v_exp_f32 v67, v67
    v_exp_f32 v68, v68
    v_cvt_pk_bf16_f32 v248, v60, v61
    v_cvt_pk_bf16_f32 v249, v62, v63
    v_cvt_pk_bf16_f32 v250, v64, v65
    v_cvt_pk_bf16_f32 v251, v66, v67
    v_mfma_f32_32x32x16_bf16 v[232:247], v[80:83], v[164:167], v[232:247]
    ds_read_b64_tr_b16 v[40:41], v97 offset:16384
    ds_read_b64_tr_b16 v[42:43], v98 offset:16384
    ds_read_b64_tr_b16 v[44:45], v97 offset:17408
    ds_read_b64_tr_b16 v[46:47], v98 offset:17408
    v_exp_f32 v69, v69
    v_exp_f32 v70, v70
    v_exp_f32 v71, v71
    v_mfma_f32_32x32x16_bf16 v[216:231], v[48:51], v[248:251], v[216:231]
    v_exp_f32 v72, v72
    v_exp_f32 v73, v73
    v_exp_f32 v74, v74
    v_exp_f32 v75, v75
    v_cvt_pk_bf16_f32 v252, v68, v69
    v_cvt_pk_bf16_f32 v253, v70, v71
    v_cvt_pk_bf16_f32 v254, v72, v73
    v_cvt_pk_bf16_f32 v255, v74, v75
    v_exp_f32 v232, v232
    v_exp_f32 v233, v233
    v_mfma_f32_32x32x16_bf16 v[216:231], v[52:55], v[252:255], v[216:231]
    v_exp_f32 v234, v234
    v_exp_f32 v235, v235
    v_exp_f32 v236, v236
    v_exp_f32 v237, v237
    s_waitcnt lgkmcnt(0)
    v_exp_f32 v238, v238
    v_exp_f32 v239, v239
    v_exp_f32 v240, v240
    v_cvt_pk_bf16_f32 v248, v232, v233
    v_cvt_pk_bf16_f32 v249, v234, v235
    v_cvt_pk_bf16_f32 v250, v236, v237
    v_cvt_pk_bf16_f32 v251, v238, v239
    v_exp_f32 v241, v241
    v_exp_f32 v242, v242
    v_exp_f32 v243, v243
    v_mfma_f32_32x32x16_bf16 v[216:231], v[40:43], v[248:251], v[216:231]
    v_exp_f32 v244, v244
    v_exp_f32 v245, v245
    v_exp_f32 v246, v246
    v_exp_f32 v247, v247
    v_cvt_pk_bf16_f32 v252, v240, v241
    v_cvt_pk_bf16_f32 v253, v242, v243
    v_cvt_pk_bf16_f32 v254, v244, v245
    v_cvt_pk_bf16_f32 v255, v246, v247
    v_lshrrev_b32 v58, 5, v1
    v_lshl_add_u32 v58, v58, 8, v99
    v_mfma_f32_32x32x16_bf16 v[216:231], v[44:47], v[252:255], v[216:231]
    s_nop 11
    v_mov_b32 v56, v228
    v_mov_b32 v57, v228
    s_nop 1
    v_permlane32_swap_b32 v56, v57
    v_rcp_f32 v57, v57
    s_nop 0
    v_mov_b32 v56, v57
    v_pk_mul_f32 v[216:217], v[216:217], v[56:57]
    v_pk_mul_f32 v[218:219], v[218:219], v[56:57]
    v_pk_mul_f32 v[220:221], v[220:221], v[56:57]
    v_pk_mul_f32 v[222:223], v[222:223], v[56:57]
    v_pk_mul_f32 v[224:225], v[224:225], v[56:57]
    v_pk_mul_f32 v[226:227], v[226:227], v[56:57]
    v_pk_mul_f32 v[228:229], v[228:229], v[56:57]
    v_pk_mul_f32 v[230:231], v[230:231], v[56:57]
    v_cvt_pk_bf16_f32 v248, v216, v217
    v_cvt_pk_bf16_f32 v249, v218, v219
    v_cvt_pk_bf16_f32 v250, v220, v221
    v_cvt_pk_bf16_f32 v251, v222, v223
    v_cvt_pk_bf16_f32 v252, v224, v225
    v_cvt_pk_bf16_f32 v253, v226, v227
    v_cvt_pk_bf16_f32 v254, v228, v229
    v_cvt_pk_bf16_f32 v255, v230, v231
    v_cndmask_b32 v254, v254, 0, s[18:19]
    v_cndmask_b32 v255, v255, 0, s[18:19]
    buffer_store_dwordx4 v[248:251], v58, s[48:51], s16 offen sc1
    buffer_store_dwordx4 v[252:255], v58, s[48:51], s16 offen offset:256 sc1
    s_barrier
    ds_read_b128 v[24:27], v14 offset:0
    ds_read_b128 v[28:31], v14 offset:2048
    ds_read_b128 v[32:35], v16 offset:0
    ds_read_b128 v[36:39], v16 offset:1024
    ds_read_b128 v[40:43], v16 offset:2048
    ds_read_b128 v[44:47], v16 offset:3072
    ds_read_b128 v[48:51], v16 offset:4096
    ds_read_b128 v[52:55], v16 offset:5120
    ds_read_b128 v[56:59], v16 offset:6144
    s_mov_b32 s10, 2
bb2_18:
    s_waitcnt lgkmcnt(6)
    v_mfma_f32_16x16x32_bf16 v[104:107], v[32:35], v[24:27], v[104:107]
    ds_read_b128 v[60:63], v15 offset:0
    v_mfma_f32_16x16x32_bf16 v[108:111], v[32:35], v[28:31], v[108:111]
    ds_read_b128 v[64:67], v15 offset:2048
    s_waitcnt lgkmcnt(7)
    v_mfma_f32_16x16x32_bf16 v[112:115], v[36:39], v[24:27], v[112:115]
    s_add_u32 s8, s8, 1
    s_cmp_eq_u32 s8, 5
    v_mfma_f32_16x16x32_bf16 v[116:119], v[36:39], v[28:31], v[116:119]
    ds_read_b128 v[68:71], v16 offset:7168
    s_waitcnt lgkmcnt(7)
    v_mfma_f32_16x16x32_bf16 v[120:123], v[40:43], v[24:27], v[120:123]
    ds_read_b128 v[72:75], v16 offset:8192
    v_mfma_f32_16x16x32_bf16 v[124:127], v[40:43], v[28:31], v[124:127]
    s_cselect_b32 s11, -4, 1
    s_cselect_b32 s8, 0, s8
    s_waitcnt lgkmcnt(7)
    v_mfma_f32_16x16x32_bf16 v[128:131], v[44:47], v[24:27], v[128:131]
    ds_read_b128 v[76:79], v16 offset:9216
    v_mfma_f32_16x16x32_bf16 v[132:135], v[44:47], v[28:31], v[132:135]
    ds_read_b128 v[80:83], v16 offset:10240
    s_waitcnt lgkmcnt(8)
    v_mfma_f32_16x16x32_bf16 v[136:139], v[48:51], v[24:27], v[136:139]
    s_mul_i32 s11, s11, 32768
    v_mfma_f32_16x16x32_bf16 v[140:143], v[48:51], v[28:31], v[140:143]
    ds_read_b128 v[84:87], v16 offset:11264
    s_waitcnt lgkmcnt(8)
    v_mfma_f32_16x16x32_bf16 v[144:147], v[52:55], v[24:27], v[144:147]
    ds_read_b128 v[88:91], v16 offset:12288
    v_mfma_f32_16x16x32_bf16 v[148:151], v[52:55], v[28:31], v[148:151]
    v_add_u32 v14, s11, v14
    s_waitcnt lgkmcnt(8)
    v_mfma_f32_16x16x32_bf16 v[152:155], v[56:59], v[24:27], v[152:155]
    ds_read_b128 v[92:95], v16 offset:13312
    v_mfma_f32_16x16x32_bf16 v[156:159], v[56:59], v[28:31], v[156:159]
    v_add_u32 v16, s11, v16
    s_barrier
    s_waitcnt lgkmcnt(6)
    v_mfma_f32_16x16x32_bf16 v[104:107], v[68:71], v[60:63], v[104:107]
    ds_read_b128 v[24:27], v14 offset:0
    v_mfma_f32_16x16x32_bf16 v[108:111], v[68:71], v[64:67], v[108:111]
    ds_read_b128 v[28:31], v14 offset:2048
    s_waitcnt lgkmcnt(7)
    v_mfma_f32_16x16x32_bf16 v[112:115], v[72:75], v[60:63], v[112:115]
    v_add_u32 v15, s11, v15
    v_mfma_f32_16x16x32_bf16 v[116:119], v[72:75], v[64:67], v[116:119]
    ds_read_b128 v[32:35], v16 offset:0
    s_waitcnt lgkmcnt(7)
    v_mfma_f32_16x16x32_bf16 v[120:123], v[76:79], v[60:63], v[120:123]
    ds_read_b128 v[36:39], v16 offset:1024
    v_mfma_f32_16x16x32_bf16 v[124:127], v[76:79], v[64:67], v[124:127]
    s_sub_u32 s10, s10, 1
    s_cmp_lg_u32 s10, 0
    s_waitcnt lgkmcnt(7)
    v_mfma_f32_16x16x32_bf16 v[128:131], v[80:83], v[60:63], v[128:131]
    ds_read_b128 v[40:43], v16 offset:2048
    v_mfma_f32_16x16x32_bf16 v[132:135], v[80:83], v[64:67], v[132:135]
    ds_read_b128 v[44:47], v16 offset:3072
    s_waitcnt lgkmcnt(8)
    v_mfma_f32_16x16x32_bf16 v[136:139], v[84:87], v[60:63], v[136:139]
    v_mfma_f32_16x16x32_bf16 v[140:143], v[84:87], v[64:67], v[140:143]
    ds_read_b128 v[48:51], v16 offset:4096
    s_waitcnt lgkmcnt(8)
    v_mfma_f32_16x16x32_bf16 v[144:147], v[88:91], v[60:63], v[144:147]
    ds_read_b128 v[52:55], v16 offset:5120
    v_mfma_f32_16x16x32_bf16 v[148:151], v[88:91], v[64:67], v[148:151]
    s_waitcnt lgkmcnt(8)
    v_mfma_f32_16x16x32_bf16 v[152:155], v[92:95], v[60:63], v[152:155]
    ds_read_b128 v[56:59], v16 offset:6144
    v_mfma_f32_16x16x32_bf16 v[156:159], v[92:95], v[64:67], v[156:159]
    s_cbranch_scc1 bb2_18
    s_waitcnt vmcnt(0)
    s_lshl_b32 s14, s17, 4
    s_add_u32 s14, s14, 131072
    v_mov_b32 v17, 0
    v_mov_b32 v18, s38
    s_mov_b64 exec, 1
    buffer_store_dword v18, v17, s[48:51], s14 offen sc1
    s_mov_b64 exec, -1
    s_mov_b32 s10, s25
bb3_19:
    s_waitcnt lgkmcnt(6)
    v_mfma_f32_16x16x32_bf16 v[104:107], v[32:35], v[24:27], v[104:107]
    ds_read_b128 v[60:63], v15 offset:0
    v_mfma_f32_16x16x32_bf16 v[108:111], v[32:35], v[28:31], v[108:111]
    ds_read_b128 v[64:67], v15 offset:2048
    s_waitcnt lgkmcnt(7)
    v_mfma_f32_16x16x32_bf16 v[112:115], v[36:39], v[24:27], v[112:115]
    s_add_u32 s8, s8, 1
    s_cmp_eq_u32 s8, 5
    v_mfma_f32_16x16x32_bf16 v[116:119], v[36:39], v[28:31], v[116:119]
    ds_read_b128 v[68:71], v16 offset:7168
    s_waitcnt lgkmcnt(7)
    v_mfma_f32_16x16x32_bf16 v[120:123], v[40:43], v[24:27], v[120:123]
    ds_read_b128 v[72:75], v16 offset:8192
    v_mfma_f32_16x16x32_bf16 v[124:127], v[40:43], v[28:31], v[124:127]
    s_cselect_b32 s11, -4, 1
    s_cselect_b32 s8, 0, s8
    s_waitcnt lgkmcnt(7)
    v_mfma_f32_16x16x32_bf16 v[128:131], v[44:47], v[24:27], v[128:131]
    ds_read_b128 v[76:79], v16 offset:9216
    v_mfma_f32_16x16x32_bf16 v[132:135], v[44:47], v[28:31], v[132:135]
    ds_read_b128 v[80:83], v16 offset:10240
    s_waitcnt lgkmcnt(8)
    v_mfma_f32_16x16x32_bf16 v[136:139], v[48:51], v[24:27], v[136:139]
    s_mul_i32 s11, s11, 32768
    v_mfma_f32_16x16x32_bf16 v[140:143], v[48:51], v[28:31], v[140:143]
    ds_read_b128 v[84:87], v16 offset:11264
    s_waitcnt lgkmcnt(8)
    v_mfma_f32_16x16x32_bf16 v[144:147], v[52:55], v[24:27], v[144:147]
    ds_read_b128 v[88:91], v16 offset:12288
    v_mfma_f32_16x16x32_bf16 v[148:151], v[52:55], v[28:31], v[148:151]
    v_add_u32 v14, s11, v14
    s_waitcnt lgkmcnt(8)
    v_mfma_f32_16x16x32_bf16 v[152:155], v[56:59], v[24:27], v[152:155]
    ds_read_b128 v[92:95], v16 offset:13312
    v_mfma_f32_16x16x32_bf16 v[156:159], v[56:59], v[28:31], v[156:159]
    v_add_u32 v16, s11, v16
    s_barrier
    s_waitcnt lgkmcnt(6)
    v_mfma_f32_16x16x32_bf16 v[104:107], v[68:71], v[60:63], v[104:107]
    ds_read_b128 v[24:27], v14 offset:0
    v_mfma_f32_16x16x32_bf16 v[108:111], v[68:71], v[64:67], v[108:111]
    ds_read_b128 v[28:31], v14 offset:2048
    s_waitcnt lgkmcnt(7)
    v_mfma_f32_16x16x32_bf16 v[112:115], v[72:75], v[60:63], v[112:115]
    v_add_u32 v15, s11, v15
    v_mfma_f32_16x16x32_bf16 v[116:119], v[72:75], v[64:67], v[116:119]
    ds_read_b128 v[32:35], v16 offset:0
    s_waitcnt lgkmcnt(7)
    v_mfma_f32_16x16x32_bf16 v[120:123], v[76:79], v[60:63], v[120:123]
    ds_read_b128 v[36:39], v16 offset:1024
    v_mfma_f32_16x16x32_bf16 v[124:127], v[76:79], v[64:67], v[124:127]
    s_sub_u32 s10, s10, 1
    s_cmp_lg_u32 s10, 0
    s_waitcnt lgkmcnt(7)
    v_mfma_f32_16x16x32_bf16 v[128:131], v[80:83], v[60:63], v[128:131]
    ds_read_b128 v[40:43], v16 offset:2048
    v_mfma_f32_16x16x32_bf16 v[132:135], v[80:83], v[64:67], v[132:135]
    ds_read_b128 v[44:47], v16 offset:3072
    s_waitcnt lgkmcnt(8)
    v_mfma_f32_16x16x32_bf16 v[136:139], v[84:87], v[60:63], v[136:139]
    v_mfma_f32_16x16x32_bf16 v[140:143], v[84:87], v[64:67], v[140:143]
    ds_read_b128 v[48:51], v16 offset:4096
    s_waitcnt lgkmcnt(8)
    v_mfma_f32_16x16x32_bf16 v[144:147], v[88:91], v[60:63], v[144:147]
    ds_read_b128 v[52:55], v16 offset:5120
    v_mfma_f32_16x16x32_bf16 v[148:151], v[88:91], v[64:67], v[148:151]
    s_waitcnt lgkmcnt(8)
    v_mfma_f32_16x16x32_bf16 v[152:155], v[92:95], v[60:63], v[152:155]
    ds_read_b128 v[56:59], v16 offset:6144
    v_mfma_f32_16x16x32_bf16 v[156:159], v[92:95], v[64:67], v[156:159]
    s_cbranch_scc1 bb3_19
    s_waitcnt lgkmcnt(6)
    v_mfma_f32_16x16x32_bf16 v[104:107], v[32:35], v[24:27], v[104:107]
    ds_read_b128 v[60:63], v15 offset:0
    v_mfma_f32_16x16x32_bf16 v[108:111], v[32:35], v[28:31], v[108:111]
    ds_read_b128 v[64:67], v15 offset:2048
    s_waitcnt lgkmcnt(7)
    v_mfma_f32_16x16x32_bf16 v[112:115], v[36:39], v[24:27], v[112:115]
    v_mfma_f32_16x16x32_bf16 v[116:119], v[36:39], v[28:31], v[116:119]
    ds_read_b128 v[68:71], v16 offset:7168
    s_waitcnt lgkmcnt(7)
    v_mfma_f32_16x16x32_bf16 v[120:123], v[40:43], v[24:27], v[120:123]
    ds_read_b128 v[72:75], v16 offset:8192
    v_mfma_f32_16x16x32_bf16 v[124:127], v[40:43], v[28:31], v[124:127]
    s_waitcnt lgkmcnt(7)
    v_mfma_f32_16x16x32_bf16 v[128:131], v[44:47], v[24:27], v[128:131]
    ds_read_b128 v[76:79], v16 offset:9216
    v_mfma_f32_16x16x32_bf16 v[132:135], v[44:47], v[28:31], v[132:135]
    ds_read_b128 v[80:83], v16 offset:10240
    s_waitcnt lgkmcnt(8)
    v_mfma_f32_16x16x32_bf16 v[136:139], v[48:51], v[24:27], v[136:139]
    v_mfma_f32_16x16x32_bf16 v[140:143], v[48:51], v[28:31], v[140:143]
    ds_read_b128 v[84:87], v16 offset:11264
    s_waitcnt lgkmcnt(8)
    v_mfma_f32_16x16x32_bf16 v[144:147], v[52:55], v[24:27], v[144:147]
    ds_read_b128 v[88:91], v16 offset:12288
    v_mfma_f32_16x16x32_bf16 v[148:151], v[52:55], v[28:31], v[148:151]
    s_waitcnt lgkmcnt(8)
    v_mfma_f32_16x16x32_bf16 v[152:155], v[56:59], v[24:27], v[152:155]
    ds_read_b128 v[92:95], v16 offset:13312
    v_mfma_f32_16x16x32_bf16 v[156:159], v[56:59], v[28:31], v[156:159]
    s_waitcnt lgkmcnt(6)
    v_mfma_f32_16x16x32_bf16 v[104:107], v[68:71], v[60:63], v[104:107]
    v_mfma_f32_16x16x32_bf16 v[108:111], v[68:71], v[64:67], v[108:111]
    s_waitcnt lgkmcnt(5)
    v_mfma_f32_16x16x32_bf16 v[112:115], v[72:75], v[60:63], v[112:115]
    v_mfma_f32_16x16x32_bf16 v[116:119], v[72:75], v[64:67], v[116:119]
    s_waitcnt lgkmcnt(4)
    v_mfma_f32_16x16x32_bf16 v[120:123], v[76:79], v[60:63], v[120:123]
    v_mfma_f32_16x16x32_bf16 v[124:127], v[76:79], v[64:67], v[124:127]
    s_waitcnt lgkmcnt(3)
    v_mfma_f32_16x16x32_bf16 v[128:131], v[80:83], v[60:63], v[128:131]
    v_mfma_f32_16x16x32_bf16 v[132:135], v[80:83], v[64:67], v[132:135]
    s_waitcnt lgkmcnt(2)
    v_mfma_f32_16x16x32_bf16 v[136:139], v[84:87], v[60:63], v[136:139]
    v_mfma_f32_16x16x32_bf16 v[140:143], v[84:87], v[64:67], v[140:143]
    s_waitcnt lgkmcnt(1)
    v_mfma_f32_16x16x32_bf16 v[144:147], v[88:91], v[60:63], v[144:147]
    v_mfma_f32_16x16x32_bf16 v[148:151], v[88:91], v[64:67], v[148:151]
    s_waitcnt lgkmcnt(0)
    v_mfma_f32_16x16x32_bf16 v[152:155], v[92:95], v[60:63], v[152:155]
    v_mfma_f32_16x16x32_bf16 v[156:159], v[92:95], v[64:67], v[156:159]
    s_waitcnt lgkmcnt(0)
    s_lshl_b32 s9, s96, 2
    s_add_u32 s9, s9, s97
    s_lshl_b32 s9, s9, 4
    s_lshl_b32 s10, s98, 2
    s_add_u32 s10, s10, s9
    s_add_u32 s10, s10, s3
    s_lshl_b32 s10, s10, 13
    s_add_u32 s10, s10, 14680064
    s_add_u32 s11, s10, 4096
    v_lshlrev_b32 v17, 4, v1
    s_cmp_lg_u32 s3, s98
    s_cselect_b64 vcc, -1, 0
    v_cvt_pk_bf16_f32 v24, v104, v105
    v_cvt_pk_bf16_f32 v25, v106, v107
    v_cvt_pk_bf16_f32 v26, v112, v113
    v_cvt_pk_bf16_f32 v27, v114, s35
    s_cbranch_vccz pub_20
    buffer_store_dwordx4 v[24:27], v17, s[48:51], s10 offen offset:0 sc1
pub_20:
    v_cvt_pk_bf16_f32 v28, v115, v120
    v_cvt_pk_bf16_f32 v29, v121, v122
    v_cvt_pk_bf16_f32 v30, v123, v128
    v_cvt_pk_bf16_f32 v31, v129, s35
    s_cbranch_vccz pub_21
    buffer_store_dwordx4 v[28:31], v17, s[48:51], s10 offen offset:1024 sc1
pub_21:
    v_cvt_pk_bf16_f32 v32, v130, v131
    v_cvt_pk_bf16_f32 v33, v136, v137
    v_cvt_pk_bf16_f32 v34, v138, v139
    v_cvt_pk_bf16_f32 v35, v144, s35
    s_cbranch_vccz pub_22
    buffer_store_dwordx4 v[32:35], v17, s[48:51], s10 offen offset:2048 sc1
pub_22:
    v_cvt_pk_bf16_f32 v36, v145, v146
    v_cvt_pk_bf16_f32 v37, v147, v152
    v_cvt_pk_bf16_f32 v38, v153, v154
    v_cvt_pk_bf16_f32 v39, v155, s35
    s_cbranch_vccz pub_23
    buffer_store_dwordx4 v[36:39], v17, s[48:51], s10 offen offset:3072 sc1
pub_23:
    v_cvt_pk_bf16_f32 v40, v108, v109
    v_cvt_pk_bf16_f32 v41, v110, v111
    v_cvt_pk_bf16_f32 v42, v116, v117
    v_cvt_pk_bf16_f32 v43, v118, s35
    s_cbranch_vccz pub_24
    buffer_store_dwordx4 v[40:43], v17, s[48:51], s11 offen offset:0 sc1
pub_24:
    v_cvt_pk_bf16_f32 v44, v119, v124
    v_cvt_pk_bf16_f32 v45, v125, v126
    v_cvt_pk_bf16_f32 v46, v127, v132
    v_cvt_pk_bf16_f32 v47, v133, s35
    s_cbranch_vccz pub_25
    buffer_store_dwordx4 v[44:47], v17, s[48:51], s11 offen offset:1024 sc1
pub_25:
    v_cvt_pk_bf16_f32 v48, v134, v135
    v_cvt_pk_bf16_f32 v49, v140, v141
    v_cvt_pk_bf16_f32 v50, v142, v143
    v_cvt_pk_bf16_f32 v51, v148, s35
    s_cbranch_vccz pub_26
    buffer_store_dwordx4 v[48:51], v17, s[48:51], s11 offen offset:2048 sc1
pub_26:
    v_cvt_pk_bf16_f32 v52, v149, v150
    v_cvt_pk_bf16_f32 v53, v151, v156
    v_cvt_pk_bf16_f32 v54, v157, v158
    v_cvt_pk_bf16_f32 v55, v159, s35
    s_cbranch_vccz pub_27
    buffer_store_dwordx4 v[52:55], v17, s[48:51], s11 offen offset:3072 sc1
pub_27:
    s_barrier
    s_cbranch_vccnz own_done
    v_add_u32 v18, 32768, v17
    ds_write_b128 v18, v[24:27] offset:0
    ds_write_b128 v18, v[28:31] offset:1024
    ds_write_b128 v18, v[32:35] offset:2048
    ds_write_b128 v18, v[36:39] offset:3072
    ds_write_b128 v18, v[40:43] offset:4096
    ds_write_b128 v18, v[44:47] offset:5120
    ds_write_b128 v18, v[48:51] offset:6144
    ds_write_b128 v18, v[52:55] offset:7168
    s_waitcnt lgkmcnt(0)
own_done:
    v_lshrrev_b32 v4, 4, v1
    v_lshlrev_b32 v4, 3, v4
    v_bfe_u32 v18, v1, 2, 2
    v_add_u32 v4, v4, v18
    v_lshlrev_b32 v4, 7, v4
    v_bfe_u32 v18, v1, 3, 2
    v_lshl_add_u32 v4, v18, 5, v4
    v_and_b32 v18, 3, v1
    v_lshl_add_u32 v4, v18, 3, v4
    v_add_u32 v4, 65536, v4
    s_and_b32 s13, s3, 1
    s_lshl_b32 s13, s13, 6
    v_xor_b32 v4, s13, v4
    v_xor_b32 v5, 32, v4
    s_lshr_b32 s15, s3, 1
    s_lshl_b32 s14, s15, 11
    s_add_u32 s14, s14, 131072
    v_add_u32 v12, s14, v17
    s_mov_b32 s11, 16384
    s_lshl_b32 s12, s101, 6
    s_lshl_b32 s15, s15, 5
    s_add_u32 s12, s12, s15
    s_mul_i32 s12, s12, 1792
    s_lshl_b32 s15, s63, 7
    s_add_u32 s12, s12, s15
    s_add_u32 s12, s12, s13
    s_add_u32 s13, s12, 28672
    v_and_b32 v17, 15, v1
    v_mul_u32_u24 v17, 1792, v17
    v_lshrrev_b32 v18, 5, v1
    v_lshl_add_u32 v17, v18, 4, v17
    v_bfe_u32 v18, v1, 4, 1
    v_lshl_add_u32 v17, v18, 5, v17
    v_mov_b32 v104, 0
    v_mov_b32 v105, 0
    v_mov_b32 v106, 0
    v_mov_b32 v107, 0
    v_mov_b32 v108, 0
    v_mov_b32 v109, 0
    v_mov_b32 v110, 0
    v_mov_b32 v111, 0
    v_mov_b32 v112, 0
    v_mov_b32 v113, 0
    v_mov_b32 v114, 0
    v_mov_b32 v115, 0
    v_mov_b32 v116, 0
    v_mov_b32 v117, 0
    v_mov_b32 v118, 0
    v_mov_b32 v119, 0
    s_barrier
    s_cmp_ge_u32 s5, 28
    s_cbranch_scc1 g0_done
    ds_read_b64_tr_b16 v[128:129], v4 offset:0
    ds_read_b64_tr_b16 v[130:131], v4 offset:512
    ds_read_b128 v[136:139], v12 offset:0
    ds_read_b128 v[140:143], v12 offset:1024
    ds_read_b64_tr_b16 v[132:133], v5 offset:0
    ds_read_b64_tr_b16 v[134:135], v5 offset:512
    ds_read_b64_tr_b16 v[144:145], v4 offset:4096
    ds_read_b64_tr_b16 v[146:147], v4 offset:4608
    ds_read_b128 v[152:155], v12 offset:4096
    ds_read_b128 v[156:159], v12 offset:5120
    ds_read_b64_tr_b16 v[148:149], v5 offset:4096
    ds_read_b64_tr_b16 v[150:151], v5 offset:4608
    s_mov_b32 s10, 0
a3_loop:
    s_waitcnt lgkmcnt(9)
    v_mfma_f32_16x16x32_bf16 v[104:107], v[128:131], v[136:139], v[104:107]
    ds_read_b64_tr_b16 v[160:161], v4 offset:8192
    ds_read_b64_tr_b16 v[162:163], v4 offset:8704
    s_waitcnt lgkmcnt(10)
    v_mfma_f32_16x16x32_bf16 v[112:115], v[128:131], v[140:143], v[112:115]
    ds_read_b128 v[168:171], v12 offset:8192
    s_waitcnt lgkmcnt(9)
    v_mfma_f32_16x16x32_bf16 v[108:111], v[132:135], v[136:139], v[108:111]
    ds_read_b128 v[172:175], v12 offset:9216
    ds_read_b64_tr_b16 v[164:165], v5 offset:8192
    v_mfma_f32_16x16x32_bf16 v[116:119], v[132:135], v[140:143], v[116:119]
    ds_read_b64_tr_b16 v[166:167], v5 offset:8704
    s_waitcnt lgkmcnt(9)
    v_mfma_f32_16x16x32_bf16 v[104:107], v[144:147], v[152:155], v[104:107]
    ds_read_b64_tr_b16 v[176:177], v4 offset:12288
    ds_read_b64_tr_b16 v[178:179], v4 offset:12800
    s_waitcnt lgkmcnt(10)
    v_mfma_f32_16x16x32_bf16 v[112:115], v[144:147], v[156:159], v[112:115]
    ds_read_b128 v[184:187], v12 offset:12288
    s_waitcnt lgkmcnt(9)
    v_mfma_f32_16x16x32_bf16 v[108:111], v[148:151], v[152:155], v[108:111]
    ds_read_b128 v[188:191], v12 offset:13312
    ds_read_b64_tr_b16 v[180:181], v5 offset:12288
    v_mfma_f32_16x16x32_bf16 v[116:119], v[148:151], v[156:159], v[116:119]
    ds_read_b64_tr_b16 v[182:183], v5 offset:12800
    s_cmp_eq_u32 s10, 1
    s_cselect_b32 s14, 16384, s11
    s_cselect_b32 s15, 4294819840, s11
    v_add_u32 v4, s14, v4
    v_add_u32 v5, s14, v5
    v_add_u32 v12, s15, v12
    s_waitcnt lgkmcnt(9)
    v_mfma_f32_16x16x32_bf16 v[104:107], v[160:163], v[168:171], v[104:107]
    ds_read_b64_tr_b16 v[128:129], v4 offset:0
    ds_read_b64_tr_b16 v[130:131], v4 offset:512
    s_waitcnt lgkmcnt(10)
    v_mfma_f32_16x16x32_bf16 v[112:115], v[160:163], v[172:175], v[112:115]
    ds_read_b128 v[136:139], v12 offset:0
    s_waitcnt lgkmcnt(9)
    v_mfma_f32_16x16x32_bf16 v[108:111], v[164:167], v[168:171], v[108:111]
    ds_read_b128 v[140:143], v12 offset:1024
    ds_read_b64_tr_b16 v[132:133], v5 offset:0
    v_mfma_f32_16x16x32_bf16 v[116:119], v[164:167], v[172:175], v[116:119]
    ds_read_b64_tr_b16 v[134:135], v5 offset:512
    s_waitcnt lgkmcnt(9)
    v_mfma_f32_16x16x32_bf16 v[104:107], v[176:179], v[184:187], v[104:107]
    ds_read_b64_tr_b16 v[144:145], v4 offset:4096
    ds_read_b64_tr_b16 v[146:147], v4 offset:4608
    s_waitcnt lgkmcnt(10)
    v_mfma_f32_16x16x32_bf16 v[112:115], v[176:179], v[188:191], v[112:115]
    ds_read_b128 v[152:155], v12 offset:4096
    s_waitcnt lgkmcnt(9)
    v_mfma_f32_16x16x32_bf16 v[108:111], v[180:183], v[184:187], v[108:111]
    ds_read_b128 v[156:159], v12 offset:5120
    ds_read_b64_tr_b16 v[148:149], v5 offset:4096
    v_mfma_f32_16x16x32_bf16 v[116:119], v[180:183], v[188:191], v[116:119]
    ds_read_b64_tr_b16 v[150:151], v5 offset:4608
    s_add_u32 s10, s10, 1
    s_cmp_lt_u32 s10, 4
    s_cbranch_scc1 a3_loop
    s_nop 7
    v_cvt_pk_bf16_f32 v60, v104, v105
    v_cvt_pk_bf16_f32 v61, v106, v107
    v_cvt_pk_bf16_f32 v62, v108, v109
    v_cvt_pk_bf16_f32 v63, v110, v111
    v_cvt_pk_bf16_f32 v64, v112, v113
    v_cvt_pk_bf16_f32 v65, v114, v115
    v_cvt_pk_bf16_f32 v66, v116, v117
    v_cvt_pk_bf16_f32 v67, v118, v119
    s_nop 1
    v_permlane16_swap_b32 v60, v62
    v_permlane16_swap_b32 v61, v63
    v_permlane16_swap_b32 v64, v66
    v_permlane16_swap_b32 v65, v67
    buffer_store_dwordx4 v[60:63], v17, s[52:55], s12 offen
    buffer_store_dwordx4 v[64:67], v17, s[52:55], s13 offen
g0_done:
    s_endpgm
k_end:
    s_endpgm
.section .rodata,"a"
.p2align 6
.amdhsa_kernel concat_heads__sliding_block__spectral_fnet__prompt_kernel
  .amdhsa_next_free_vgpr 256
  .amdhsa_next_free_sgpr 102
  .amdhsa_accum_offset 256
  .amdhsa_group_segment_fixed_size 0
  .amdhsa_kernarg_size 88
  .amdhsa_user_sgpr_count 2
  .amdhsa_user_sgpr_kernarg_segment_ptr 1
  .amdhsa_system_sgpr_workgroup_id_x 1
.end_amdhsa_kernel
```
